```python
import torch

def _softmax(x, axis=-1):
    return torch.softmax(x, dim=axis)

def _gelu(x):
    return torch.nn.functional.gelu(x, approximate='tanh')

def _silu(x):
    return torch.nn.functional.silu(x)

def _sigmoid(x):
    return torch.sigmoid(x)

def _layernorm(x, axis=-1, eps=1e-05):
    m = x.mean(dim=axis, keepdim=True)
    v = x.var(dim=axis, keepdim=True, unbiased=False)
    return (x - m) / torch.sqrt(v + eps)

def _scatter_add(tgt, idx, src, axis=0):
    return tgt.clone().index_add_(axis, idx, src)

def _segment_sum(src, seg, n):
    out = torch.zeros((n,) + src.shape[1:], dtype=src.dtype)
    return out.index_add_(0, seg, src)

def _pad(x, pw):
    flat = tuple((v for pair in reversed(pw) for v in pair))
    return torch.nn.functional.pad(x, flat)
kernel_name = 'interleave_layers__spectral_fnet__mixer_gmlp__prompt'

def setup_inputs():

    _w = lambda a: (lambda t: t.to(torch.bfloat16) if t.is_floating_point() else t)(torch.as_tensor(a))

    def _A_setup():
        B, S, D = (1, 2048, 1024)
        ns = torch.arange(S)[:, None] * torch.arange(S)[None, :]
        nd = torch.arange(D)[:, None] * torch.arange(D)[None, :]
        Ws_re = torch.cos(-2.0 * torch.pi * ns / S).to(float)
        Ws_im = torch.sin(-2.0 * torch.pi * ns / S).to(float)
        Wd_re = torch.cos(-2.0 * torch.pi * nd / D).to(float)
        Wd_im = torch.sin(-2.0 * torch.pi * nd / D).to(float)
        return {'x': _w((lambda *s: torch.randn(*s, dtype=torch.bfloat16) * 0.05)(B, S, D)), 'dft_seq_re': _w(Ws_re), 'dft_seq_im': _w(Ws_im), 'dft_hid_re': _w(Wd_re), 'dft_hid_im': _w(Wd_im)}
    _A_in = _A_setup()

    def _B_setup():
        B, S, D, F = (1, 2048, 1024, 3584)
        Fh = F // 2
        return {'x': _w((lambda *s: torch.randn(*s, dtype=torch.bfloat16) * 0.05)(B, S, D)), 'w_in': _w((lambda *s: torch.randn(*s, dtype=torch.bfloat16) * 1.6)(D, 2 * Fh)), 'w_sp': _w(0.01 * (lambda *s: torch.randn(*s, dtype=torch.bfloat16) * 1.6)(S, S)), 'b_sp': _w(1.0 + 0.01 * (lambda *s: torch.randn(*s, dtype=torch.bfloat16) * 1.6)(S)), 'w_out': _w((lambda *s: torch.randn(*s, dtype=torch.bfloat16) * 1.6)(Fh, D))}
    _B_in = _B_setup()
    return {'A_x': _A_in['x'], 'A_dft_seq_re': _A_in['dft_seq_re'], 'A_dft_seq_im': _A_in['dft_seq_im'], 'A_dft_hid_re': _A_in['dft_hid_re'], 'A_dft_hid_im': _A_in['dft_hid_im'], 'B_x': _B_in['x'], 'B_w_in': _B_in['w_in'], 'B_w_sp': _B_in['w_sp'], 'B_b_sp': _B_in['b_sp'], 'B_w_out': _B_in['w_out']}

def reference(A_x, A_dft_seq_re, A_dft_seq_im, A_dft_hid_re, A_dft_hid_im, B_x, B_w_in, B_w_sp, B_b_sp, B_w_out):

    def _A_ref(x, dft_seq_re, dft_seq_im, dft_hid_re, dft_hid_im):
        a = torch.einsum('bsd,ed->bse', x, dft_hid_re)
        b = torch.einsum('bsd,ed->bse', x, dft_hid_im)
        y = torch.einsum('ts,bse->bte', dft_seq_re, a) - torch.einsum('ts,bse->bte', dft_seq_im, b)
        return y

    def _B_ref(x, w_in, w_sp, b_sp, w_out):
        B, S, D = x.shape
        F = w_in.shape[-1]
        Fh = F // 2
        z = _gelu(torch.einsum('bsd,df->bsf', x, w_in))
        z1 = z[..., :Fh].clone()
        z2 = _layernorm(z[..., Fh:], axis=-1)
        g = torch.einsum('ts,bsf->btf', w_sp, z2) + b_sp[None, :, None]
        return torch.einsum('bsf,fd->bsd', z1 * g, w_out)
    x = A_x
    x = x + _A_ref(_layernorm(x, axis=-1), A_dft_seq_re, A_dft_seq_im, A_dft_hid_re, A_dft_hid_im)
    x = x + _B_ref(_layernorm(x, axis=-1), B_w_in, B_w_sp, B_b_sp, B_w_out)
    x = x + _A_ref(_layernorm(x, axis=-1), A_dft_seq_re, A_dft_seq_im, A_dft_hid_re, A_dft_hid_im)
    x = x + _B_ref(_layernorm(x, axis=-1), B_w_in, B_w_sp, B_b_sp, B_w_out)
    return x
```

```asm
; @launch kernel=pre_kernel grid=(512,1,1) block=(256,1,1) lds=18432
; @launch kernel=gf_kernel grid=(256,1,1) block=(512,1,1) lds=155776
.amdgcn_target "amdgcn-amd-amdhsa--gfx950"
.text

.globl pre_kernel
.p2align 8
.type pre_kernel,@function
pre_kernel:
    s_cmp_ge_u32 s2, 256
    s_cbranch_scc1 end_1
    s_load_dwordx2 s[38:39], s[0:1], 96
    s_load_dwordx2 s[40:41], s[0:1], 0
    v_mov_b32 v1, v0
    v_lshrrev_b32 v2, 6, v0
    v_and_b32 v0, 63, v0
    v_readfirstlane_b32 s3, v2
    s_lshr_b32 s16, s2, 3
    s_and_b32 s17, s2, 7
    s_lshl_b32 s18, s16, 17
    s_lshl_b32 s19, s17, 8
    s_add_u32 s18, s18, s19
    v_lshrrev_b32 v2, 4, v1
    v_and_b32 v3, 15, v1
    v_lshlrev_b32 v4, 11, v2
    v_lshl_add_u32 v4, v3, 4, v4
    v_mul_u32_u24 v5, 288, v2
    v_lshl_add_u32 v5, v3, 4, v5
    s_lshl_b32 s20, s2, 2
    s_add_u32 s20, s20, s3
    s_lshl_b32 s21, s20, 12
    v_lshlrev_b32 v6, 4, v0
    s_waitcnt lgkmcnt(0)
    s_add_u32 s4, s40, 0
    s_addc_u32 s5, s41, 0
    s_mov_b32 s6, 4194304
    s_mov_b32 s7, 0x20000
    buffer_load_dwordx4 v[16:19], v4, s[4:7], s18 offen
    s_add_u32 s18, s18, 32768
    buffer_load_dwordx4 v[20:23], v4, s[4:7], s18 offen
    s_add_u32 s18, s18, 32768
    buffer_load_dwordx4 v[24:27], v4, s[4:7], s18 offen
    s_add_u32 s18, s18, 32768
    buffer_load_dwordx4 v[28:31], v4, s[4:7], s18 offen
    buffer_load_dwordx4 v[32:35], v6, s[4:7], s21 offen offset:0
    buffer_load_dwordx4 v[36:39], v6, s[4:7], s21 offen offset:1024
    buffer_load_dwordx4 v[40:43], v6, s[4:7], s21 offen offset:2048
    buffer_load_dwordx4 v[44:47], v6, s[4:7], s21 offen offset:3072
    s_add_u32 s8, s38, 46137344
    s_addc_u32 s9, s39, 0
    s_mov_b32 s10, 65536
    s_mov_b32 s11, 0x20000
    v_mov_b32 v8, 0
    v_mov_b32 v9, 0
    v_mov_b32 v10, 0
    v_mov_b32 v11, 0
    s_mul_i32 s22, s2, 192
    s_add_u32 s22, s22, 16384
    v_lshlrev_b32 v7, 4, v1
    v_cmp_gt_u32 vcc, 12, v1
    v_mov_b32 v12, 0x7fffff00
    s_nop 0
    v_cndmask_b32 v7, v12, v7, vcc
    buffer_store_dwordx4 v[8:11], v7, s[8:11], s22 offen sc1
    s_waitcnt vmcnt(8)
    ds_write_b128 v5, v[16:19] offset:0
    s_waitcnt vmcnt(7)
    ds_write_b128 v5, v[20:23] offset:4608
    s_waitcnt vmcnt(6)
    ds_write_b128 v5, v[24:27] offset:9216
    s_waitcnt vmcnt(5)
    ds_write_b128 v5, v[28:31] offset:13824
    v_bfe_u32 v2, v0, 2, 2
    v_lshrrev_b32 v3, 4, v0
    v_lshl_add_u32 v2, v3, 3, v2
    v_mul_u32_u24 v2, 288, v2
    v_and_b32 v4, 3, v0
    v_lshl_add_u32 v2, v4, 3, v2
    s_lshl_b32 s22, s3, 6
    v_add_u32 v2, s22, v2
    v_and_b32 v4, 15, v0
    v_lshlrev_b32 v4, 12, v4
    v_lshl_add_u32 v4, v3, 4, v4
    s_lshl_b32 s22, s17, 19
    s_lshl_b32 s23, s3, 17
    s_add_u32 s22, s22, s23
    s_lshl_b32 s23, s16, 7
    s_add_u32 s22, s22, s23
    s_add_u32 s23, s22, 65536
    s_add_u32 s12, s38, 0
    s_addc_u32 s13, s39, 0
    s_mov_b32 s14, 4194304
    s_mov_b32 s15, 0x20000
    s_waitcnt lgkmcnt(0)
    s_barrier
    ds_read_b64_tr_b16 v[16:17], v2 offset:0
    ds_read_b64_tr_b16 v[18:19], v2 offset:1152
    ds_read_b64_tr_b16 v[20:21], v2 offset:9216
    ds_read_b64_tr_b16 v[22:23], v2 offset:10368
    ds_read_b64_tr_b16 v[24:25], v2 offset:32
    ds_read_b64_tr_b16 v[26:27], v2 offset:1184
    ds_read_b64_tr_b16 v[28:29], v2 offset:9248
    ds_read_b64_tr_b16 v[30:31], v2 offset:10400
    s_waitcnt vmcnt(1)
    v_lshlrev_b32 v48, 16, v32
    v_and_b32 v49, 0xffff0000, v32
    v_lshlrev_b32 v50, 16, v33
    v_and_b32 v51, 0xffff0000, v33
    v_lshlrev_b32 v52, 16, v34
    v_and_b32 v53, 0xffff0000, v34
    v_lshlrev_b32 v54, 16, v35
    v_and_b32 v55, 0xffff0000, v35
    v_lshlrev_b32 v56, 16, v36
    v_and_b32 v57, 0xffff0000, v36
    v_lshlrev_b32 v58, 16, v37
    v_and_b32 v59, 0xffff0000, v37
    v_lshlrev_b32 v60, 16, v38
    v_and_b32 v61, 0xffff0000, v38
    v_lshlrev_b32 v62, 16, v39
    v_and_b32 v63, 0xffff0000, v39
    v_lshlrev_b32 v64, 16, v40
    v_and_b32 v65, 0xffff0000, v40
    v_lshlrev_b32 v66, 16, v41
    v_and_b32 v67, 0xffff0000, v41
    v_lshlrev_b32 v68, 16, v42
    v_and_b32 v69, 0xffff0000, v42
    v_lshlrev_b32 v70, 16, v43
    v_and_b32 v71, 0xffff0000, v43
    v_lshlrev_b32 v72, 16, v44
    v_and_b32 v73, 0xffff0000, v44
    v_lshlrev_b32 v74, 16, v45
    v_and_b32 v75, 0xffff0000, v45
    v_lshlrev_b32 v76, 16, v46
    v_and_b32 v77, 0xffff0000, v46
    v_lshlrev_b32 v78, 16, v47
    v_and_b32 v79, 0xffff0000, v47
    s_waitcnt lgkmcnt(6)
    buffer_store_dwordx4 v[16:19], v4, s[12:15], s22 offen offset:0 sc1
    s_waitcnt lgkmcnt(4)
    buffer_store_dwordx4 v[20:23], v4, s[12:15], s22 offen offset:64 sc1
    s_waitcnt lgkmcnt(2)
    buffer_store_dwordx4 v[24:27], v4, s[12:15], s23 offen offset:0 sc1
    s_waitcnt lgkmcnt(0)
    buffer_store_dwordx4 v[28:31], v4, s[12:15], s23 offen offset:64 sc1
    v_pk_add_f32 v[32:33], v[48:49], v[50:51]
    v_pk_mul_f32 v[34:35], v[48:49], v[48:49]
    v_pk_add_f32 v[36:37], v[64:65], v[66:67]
    v_pk_mul_f32 v[38:39], v[64:65], v[64:65]
    v_pk_fma_f32 v[34:35], v[50:51], v[50:51], v[34:35]
    v_pk_fma_f32 v[38:39], v[66:67], v[66:67], v[38:39]
    v_pk_add_f32 v[32:33], v[32:33], v[52:53]
    v_pk_fma_f32 v[34:35], v[52:53], v[52:53], v[34:35]
    v_pk_add_f32 v[36:37], v[36:37], v[68:69]
    v_pk_fma_f32 v[38:39], v[68:69], v[68:69], v[38:39]
    v_pk_add_f32 v[32:33], v[32:33], v[54:55]
    v_pk_fma_f32 v[34:35], v[54:55], v[54:55], v[34:35]
    v_pk_add_f32 v[36:37], v[36:37], v[70:71]
    v_pk_fma_f32 v[38:39], v[70:71], v[70:71], v[38:39]
    v_pk_add_f32 v[32:33], v[32:33], v[56:57]
    v_pk_fma_f32 v[34:35], v[56:57], v[56:57], v[34:35]
    v_pk_add_f32 v[36:37], v[36:37], v[72:73]
    v_pk_fma_f32 v[38:39], v[72:73], v[72:73], v[38:39]
    v_pk_add_f32 v[32:33], v[32:33], v[58:59]
    v_pk_fma_f32 v[34:35], v[58:59], v[58:59], v[34:35]
    v_pk_add_f32 v[36:37], v[36:37], v[74:75]
    v_pk_fma_f32 v[38:39], v[74:75], v[74:75], v[38:39]
    v_pk_add_f32 v[32:33], v[32:33], v[60:61]
    v_pk_fma_f32 v[34:35], v[60:61], v[60:61], v[34:35]
    v_pk_add_f32 v[36:37], v[36:37], v[76:77]
    v_pk_fma_f32 v[38:39], v[76:77], v[76:77], v[38:39]
    v_pk_add_f32 v[32:33], v[32:33], v[62:63]
    v_pk_fma_f32 v[34:35], v[62:63], v[62:63], v[34:35]
    v_pk_add_f32 v[36:37], v[36:37], v[78:79]
    v_pk_fma_f32 v[38:39], v[78:79], v[78:79], v[38:39]
    v_add_f32 v40, v32, v33
    v_add_f32 v41, v34, v35
    v_add_f32 v42, v36, v37
    v_add_f32 v43, v38, v39
    s_nop 1
    v_add_f32_dpp v40, v40, v40 quad_perm:[1,0,3,2] row_mask:0xf bank_mask:0xf
    v_add_f32_dpp v41, v41, v41 quad_perm:[1,0,3,2] row_mask:0xf bank_mask:0xf
    v_add_f32_dpp v42, v42, v42 quad_perm:[1,0,3,2] row_mask:0xf bank_mask:0xf
    v_add_f32_dpp v43, v43, v43 quad_perm:[1,0,3,2] row_mask:0xf bank_mask:0xf
    s_nop 1
    v_add_f32_dpp v40, v40, v40 quad_perm:[2,3,0,1] row_mask:0xf bank_mask:0xf
    v_add_f32_dpp v41, v41, v41 quad_perm:[2,3,0,1] row_mask:0xf bank_mask:0xf
    v_add_f32_dpp v42, v42, v42 quad_perm:[2,3,0,1] row_mask:0xf bank_mask:0xf
    v_add_f32_dpp v43, v43, v43 quad_perm:[2,3,0,1] row_mask:0xf bank_mask:0xf
    s_nop 1
    v_add_f32_dpp v40, v40, v40 row_half_mirror row_mask:0xf bank_mask:0xf
    v_add_f32_dpp v41, v41, v41 row_half_mirror row_mask:0xf bank_mask:0xf
    v_add_f32_dpp v42, v42, v42 row_half_mirror row_mask:0xf bank_mask:0xf
    v_add_f32_dpp v43, v43, v43 row_half_mirror row_mask:0xf bank_mask:0xf
    s_nop 1
    v_add_f32_dpp v40, v40, v40 row_mirror row_mask:0xf bank_mask:0xf
    v_add_f32_dpp v41, v41, v41 row_mirror row_mask:0xf bank_mask:0xf
    v_add_f32_dpp v42, v42, v42 row_mirror row_mask:0xf bank_mask:0xf
    v_add_f32_dpp v43, v43, v43 row_mirror row_mask:0xf bank_mask:0xf
    v_mov_b32 v44, v40
    v_mov_b32 v45, v41
    v_mov_b32 v46, v42
    v_mov_b32 v47, v43
    s_nop 1
    v_permlane16_swap_b32 v40, v44
    v_permlane16_swap_b32 v41, v45
    v_permlane16_swap_b32 v42, v46
    v_permlane16_swap_b32 v43, v47
    s_nop 1
    v_add_f32 v40, v40, v44
    v_add_f32 v41, v41, v45
    v_add_f32 v42, v42, v46
    v_add_f32 v43, v43, v47
    v_mov_b32 v44, v40
    v_mov_b32 v45, v41
    v_mov_b32 v46, v42
    v_mov_b32 v47, v43
    s_nop 1
    v_permlane32_swap_b32 v40, v44
    v_permlane32_swap_b32 v41, v45
    v_permlane32_swap_b32 v42, v46
    v_permlane32_swap_b32 v43, v47
    s_nop 1
    v_add_f32 v40, v40, v44
    v_add_f32 v41, v41, v45
    v_add_f32 v42, v42, v46
    v_add_f32 v43, v43, v47
    s_lshl_b32 s22, s20, 4
    v_cmp_eq_u32 vcc, 0, v0
    s_nop 1
    v_cndmask_b32 v7, v12, v0, vcc
    buffer_store_dwordx4 v[40:43], v7, s[8:11], s22 offen sc1
    s_endpgm
end_1:
    s_cmp_ge_u32 s2, 512
    s_cbranch_scc1 pfend_2
    s_load_dwordx2 s[4:5], s[0:1], 48
    s_sub_u32 s16, s2, 256
    s_mul_i32 s16, s16, 14336
    s_add_u32 s16, s16, 3670016
    v_lshlrev_b32 v1, 4, v0
    s_mov_b32 s6, 7340032
    s_mov_b32 s7, 0x20000
    s_waitcnt lgkmcnt(0)
    buffer_load_dwordx4 v[4:7], v1, s[4:7], s16 offen
    s_add_u32 s16, s16, 4096
    buffer_load_dwordx4 v[8:11], v1, s[4:7], s16 offen
    s_add_u32 s16, s16, 4096
    buffer_load_dwordx4 v[12:15], v1, s[4:7], s16 offen
    s_add_u32 s16, s16, 4096
    buffer_load_dwordx4 v[16:19], v1, s[4:7], s16 offen
    s_add_u32 s16, s16, 4096
    s_getpc_b64 s[8:9]
pc_3:
    s_sub_u32 s8, s8, pc_3-pre_kernel
    s_subb_u32 s9, s9, 0
    s_mov_b32 s10, code_end-pre_kernel
    s_mov_b32 s11, 0x20000
    s_sub_u32 s16, s2, 256
    s_lshr_b32 s16, s16, 3
    s_lshl_b32 s16, s16, 11
    v_lshlrev_b32 v2, 3, v0
    buffer_load_dwordx2 v[40:41], v2, s[8:11], s16 offen
pfend_2:
    s_endpgm

.globl gf_kernel
.p2align 8
.type gf_kernel,@function
gf_kernel:
    s_mov_b32 s33, 0
    s_mov_b32 s32, 0
gf_body_4:
    s_cmp_ge_u32 s2, 256
    s_cbranch_scc1 end_5
    s_load_dwordx2 s[38:39], s[0:1], 96
    s_load_dwordx8 s[68:75], s[0:1], 48
    s_load_dwordx2 s[76:77], s[0:1], 80
    v_lshrrev_b32 v2, 6, v0
    v_and_b32 v0, 63, v0
    v_readfirstlane_b32 s3, v2
    s_mov_b32 s79, 155648
    v_and_b32 v204, 7, v0
    v_lshlrev_b32 v204, 4, v204
    v_add_u32 v204, s79, v204
    v_mov_b32 v200, 0
    v_mov_b32 v201, 0
    v_mov_b32 v202, 0
    v_mov_b32 v203, 0
    ds_write_b128 v204, v[200:203]
layer_7:
    s_lshl_b32 s16, s3, 6
    v_add_u32 v1, s16, v0
    v_lshlrev_b32 v2, 5, v1
    v_lshlrev_b32 v3, 3, v1
    s_lshr_b32 s16, s2, 5
    s_lshl_b32 s16, s16, 7
    s_and_b32 s17, s2, 31
    s_add_u32 s16, s16, s17
    s_lshl_b32 s16, s16, 12
    s_lshl_b32 s25, s33, 14
    s_add_u32 s25, s25, 46137344
    s_and_b32 s20, s3, 1
    s_bfe_u32 s21, s3, 0x10001
    s_lshr_b32 s22, s3, 2
    v_and_b32 v4, 15, v0
    v_lshrrev_b32 v5, 4, v0
    v_lshlrev_b32 v5, 2, v5
    s_lshl_b32 s23, s20, 4
    v_add_u32 v6, s23, v4
    v_cvt_f32_u32 v6, v6
    v_lshlrev_b32 v8, 4, v0
    s_lshr_b32 s27, s3, 1
    s_lshl_b32 s24, s27, 4
    v_add_u32 v7, s24, v5
    v_cvt_f32_u32 v7, v7
    v_mul_f32 v111, 3162505216, v6
    v_mul_f32 v108, v111, v7
    v_add_f32 v109, v108, v111
    v_add_f32 v110, v109, v111
    v_add_f32 v111, v110, v111
    v_cos_f32 v104, v108
    v_sin_f32 v108, v108
    v_cos_f32 v105, v109
    v_sin_f32 v109, v109
    v_cos_f32 v106, v110
    v_sin_f32 v110, v110
    v_cos_f32 v107, v111
    v_sin_f32 v111, v111
    s_lshl_b32 s24, s22, 1
    s_add_u32 s24, s24, s20
    s_lshl_b32 s24, s24, 11
    s_lshl_b32 s26, s21, 3
    s_add_u32 s24, s24, s26
    v_add_u32 v9, s24, v8
    v_mul_f32 v104, 1031798784, v104
    v_mul_f32 v105, 1031798784, v105
    v_mul_f32 v106, 1031798784, v106
    v_mul_f32 v107, 1031798784, v107
    v_mul_f32 v108, 1031798784, v108
    v_mul_f32 v109, 1031798784, v109
    v_mul_f32 v110, 1031798784, v110
    v_mul_f32 v111, 1031798784, v111
    v_cvt_pk_f16_f32 v112, v104, v105
    v_cvt_pk_f16_f32 v113, v106, v107
    v_cvt_pk_f16_f32 v114, v108, v109
    v_cvt_pk_f16_f32 v115, v110, v111
    ds_write_b64 v9, v[112:113] offset:53248
    ds_write_b64 v9, v[114:115] offset:54272
    v_cvt_f32_u32 v7, v5
    v_mul_f32 v24, 3170893824, v6
    v_mul_f32 v25, v24, v7
    v_mov_b32 v20, v25
    v_fmamk_f32 v21, v24, 1065353216, v25
    v_fmamk_f32 v22, v24, 1073741824, v25
    v_fmamk_f32 v23, v24, 1077936128, v25
    v_cos_f32 v16, v20
    v_sin_f32 v20, v20
    v_cos_f32 v17, v21
    v_sin_f32 v21, v21
    v_cos_f32 v18, v22
    v_sin_f32 v22, v22
    v_cos_f32 v19, v23
    v_sin_f32 v23, v23
    s_nop 0
    v_cvt_pk_f16_f32 v32, v16, v17
    v_cvt_pk_f16_f32 v36, v20, v21
    v_cvt_pk_f16_f32 v33, v18, v19
    v_cvt_pk_f16_f32 v37, v22, v23
    v_fmamk_f32 v20, v24, 1098907648, v25
    v_fmamk_f32 v21, v24, 1099431936, v25
    v_fmamk_f32 v22, v24, 1099956224, v25
    v_fmamk_f32 v23, v24, 1100480512, v25
    v_cos_f32 v16, v20
    v_sin_f32 v20, v20
    v_cos_f32 v17, v21
    v_sin_f32 v21, v21
    v_cos_f32 v18, v22
    v_sin_f32 v22, v22
    v_cos_f32 v19, v23
    v_sin_f32 v23, v23
    s_nop 0
    v_cvt_pk_f16_f32 v34, v16, v17
    v_cvt_pk_f16_f32 v38, v20, v21
    v_cvt_pk_f16_f32 v35, v18, v19
    v_cvt_pk_f16_f32 v39, v22, v23
    s_waitcnt lgkmcnt(0)
    s_cmp_eq_u32 s33, 0
    s_cbranch_scc1 nosync_9
    v_mov_b32 v200, s79
    v_mov_b32 v201, 1
    s_cmp_eq_u32 s3, 4
    s_cselect_b32 s80, 512, 1
    s_cselect_b32 s81, 0, 4
    v_add_u32 v202, s81, v200
    s_lshl_b32 s86, s33, 14
    s_add_u32 s86, s86, 46170112
    s_add_u32 s84, s38, s86
    s_addc_u32 s85, s39, 0
    s_mov_b32 s86, 16384
    s_mov_b32 s87, 0x20000
    v_mov_b32 v203, 0x10000
    v_mov_b32 v206, 0x10000
    s_lshr_b32 s82, s2, 4
    s_lshl_b32 s82, s82, 7
    v_writelane_b32 v203, s82, 0
    s_and_b32 s82, s2, 15
    s_lshl_b32 s82, s82, 7
    v_writelane_b32 v206, s82, 0
    v_lshlrev_b32 v204, 7, v0
    v_and_b32 v205, 48, v0
    v_lshl_add_u32 v204, v205, 12, v204
    s_mov_b32 s82, 6144
    s_mov_b32 s83, 10240
    s_mov_b32 s88, 0x40000
    s_waitcnt vmcnt(0) lgkmcnt(0)
    ds_add_u32 v200, v201 offset:32
gsp_10:
    ds_read_b32 v205, v202 offset:32
    s_sub_u32 s88, s88, 1
    s_waitcnt lgkmcnt(0)
    v_readfirstlane_b32 s89, v205
    s_cmp_eq_u32 s88, 0
    s_cbranch_scc1 gw_11
    s_cmp_ge_u32 s89, s80
    s_cbranch_scc1 gw_11
    s_sleep 1
    s_branch gsp_10
gw_11:
    s_cmp_lg_u32 s3, 4
    s_cbranch_scc1 gok_12
    s_mov_b32 s88, 0x4000
    v_mov_b32 v205, 1
    buffer_atomic_add v205, v203, s[84:87], s82 offen sc0 sc1
    s_waitcnt vmcnt(0)
    v_readfirstlane_b32 s89, v205
    s_cmp_lg_u32 s89, 15
    s_cbranch_scc1 gpo_13
    buffer_atomic_add v201, v204, s[84:87], s83 offen sc1
gpo_13:
    v_mov_b32 v205, 0
    buffer_atomic_add v205, v206, s[84:87], s83 offen sc0 sc1
    s_sub_u32 s88, s88, 1
    s_waitcnt vmcnt(0)
    v_readfirstlane_b32 s89, v205
    s_cmp_eq_u32 s88, 0
    s_cbranch_scc1 ggo_14
    s_cmp_lt_u32 s89, 16
    s_cbranch_scc1 gpo_13
ggo_14:
    ds_write_b32 v200, v200 offset:36
gok_12:
nosync_9:
    s_setprio 2
    s_add_u32 s4, s38, s25
    s_addc_u32 s5, s39, 0
    s_mov_b32 s6, 16384
    s_mov_b32 s7, 0x20000
    s_add_u32 s10, s32, 0
    s_add_u32 s8, s38, s10
    s_addc_u32 s9, s39, 0
    s_mov_b32 s10, 4194304
    s_mov_b32 s11, 0x20000
    buffer_load_dwordx4 v[72:75], v2, s[4:7], 0 offen offset:0
    buffer_load_dwordx4 v[76:79], v2, s[4:7], 0 offen offset:16
    buffer_load_dwordx2 v[80:81], v3, s[8:11], s16 offen
    s_add_u32 s16, s16, 131072
    buffer_load_dwordx2 v[82:83], v3, s[8:11], s16 offen
    s_add_u32 s16, s16, 131072
    buffer_load_dwordx2 v[84:85], v3, s[8:11], s16 offen
    s_add_u32 s16, s16, 131072
    buffer_load_dwordx2 v[86:87], v3, s[8:11], s16 offen
    s_add_u32 s86, s32, 47185920
    s_add_u32 s84, s38, s86
    s_addc_u32 s85, s39, 0
    s_mov_b32 s86, 524288
    s_mov_b32 s87, 0x20000
    v_mov_b32 v208, -1
    v_mov_b32 v209, -1
    v_mov_b32 v210, -1
    v_mov_b32 v211, -1
    s_lshl_b32 s16, s2, 3
    s_add_u32 s16, s16, s3
    s_lshl_b32 s16, s16, 8
    v_and_b32 v212, 48, v0
    v_lshl_add_u32 v212, v212, 20, v8
    buffer_store_dwordx4 v[208:211], v212, s[84:87], s16 offen sc1
    v_mul_f32 v16, 3120562176, v6
    v_mul_f32 v17, v16, v7
    v_mov_b32 v44, v17
    v_fmamk_f32 v45, v16, 1065353216, v17
    v_fmamk_f32 v46, v16, 1073741824, v17
    v_fmamk_f32 v47, v16, 1077936128, v17
    v_fmamk_f32 v52, v16, 1098907648, v17
    v_fmamk_f32 v53, v16, 1099431936, v17
    v_fmamk_f32 v54, v16, 1099956224, v17
    v_fmamk_f32 v55, v16, 1100480512, v17
    v_fmamk_f32 v60, v16, 1107296256, v17
    v_fmamk_f32 v61, v16, 1107558400, v17
    v_fmamk_f32 v62, v16, 1107820544, v17
    v_fmamk_f32 v63, v16, 1108082688, v17
    v_fmamk_f32 v68, v16, 1111490560, v17
    v_fmamk_f32 v69, v16, 1111752704, v17
    v_fmamk_f32 v70, v16, 1112014848, v17
    v_fmamk_f32 v71, v16, 1112276992, v17
    v_cos_f32 v40, v44
    v_sin_f32 v44, v44
    v_cos_f32 v41, v45
    v_sin_f32 v45, v45
    v_cos_f32 v42, v46
    v_sin_f32 v46, v46
    v_cos_f32 v43, v47
    v_sin_f32 v47, v47
    v_cos_f32 v48, v52
    v_sin_f32 v52, v52
    v_cos_f32 v49, v53
    v_sin_f32 v53, v53
    v_cos_f32 v50, v54
    v_sin_f32 v54, v54
    v_cos_f32 v51, v55
    v_sin_f32 v55, v55
    v_cos_f32 v56, v60
    v_sin_f32 v60, v60
    v_cos_f32 v57, v61
    v_sin_f32 v61, v61
    v_cos_f32 v58, v62
    v_sin_f32 v62, v62
    v_cos_f32 v59, v63
    v_sin_f32 v63, v63
    v_cos_f32 v64, v68
    v_sin_f32 v68, v68
    v_cos_f32 v65, v69
    v_sin_f32 v69, v69
    v_cos_f32 v66, v70
    v_sin_f32 v70, v70
    v_cos_f32 v67, v71
    v_sin_f32 v71, v71
    v_lshrrev_b32 v6, 4, v1
    v_mul_u32_u24 v6, 160, v6
    v_and_b32 v7, 15, v1
    v_lshl_add_u32 v6, v7, 3, v6
    v_lshrrev_b32 v9, 2, v0
    v_mul_u32_u24 v9, 160, v9
    v_and_b32 v7, 3, v0
    v_lshl_add_u32 v9, v7, 3, v9
    s_mul_i32 s16, s27, 5120
    v_add_u32 v9, s16, v9
    s_waitcnt vmcnt(5)
    v_mul_f32 v72, 981467136, v72
    v_mul_f32 v73, 981467136, v73
    v_mul_f32 v74, 981467136, v74
    v_mul_f32 v75, 981467136, v75
    v_mul_f32 v76, 981467136, v76
    v_mul_f32 v77, 981467136, v77
    v_mul_f32 v78, 981467136, v78
    v_mul_f32 v79, 981467136, v79
    v_fma_f32 v73, -v72, v72, v73
    v_fma_f32 v75, -v74, v74, v75
    v_fma_f32 v77, -v76, v76, v77
    v_fma_f32 v79, -v78, v78, v79
    v_max_f32 v73, 0, v73
    v_add_f32 v73, 925353388, v73
    v_max_f32 v75, 0, v75
    v_add_f32 v75, 925353388, v75
    v_max_f32 v77, 0, v77
    v_add_f32 v77, 925353388, v77
    v_max_f32 v79, 0, v79
    v_add_f32 v79, 925353388, v79
    v_rsq_f32 v88, v73
    v_rsq_f32 v89, v75
    v_rsq_f32 v90, v77
    v_rsq_f32 v91, v79
    s_nop 0
    v_mul_f32 v92, -v72, v88
    v_mul_f32 v93, -v74, v89
    v_mul_f32 v94, -v76, v90
    v_mul_f32 v95, -v78, v91
    s_waitcnt vmcnt(4)
    v_lshlrev_b32 v96, 16, v80
    v_and_b32 v97, 0xffff0000, v80
    v_lshlrev_b32 v98, 16, v81
    v_and_b32 v99, 0xffff0000, v81
    v_fma_f32 v96, v96, v88, v92
    v_fma_f32 v97, v97, v89, v93
    v_fma_f32 v98, v98, v90, v94
    v_fma_f32 v99, v99, v91, v95
    v_cvt_pk_f16_f32 v80, v96, v97
    v_cvt_pk_f16_f32 v81, v98, v99
    ds_write_b64 v6, v[80:81] offset:0
    s_waitcnt vmcnt(3)
    v_lshlrev_b32 v96, 16, v82
    v_and_b32 v97, 0xffff0000, v82
    v_lshlrev_b32 v98, 16, v83
    v_and_b32 v99, 0xffff0000, v83
    v_fma_f32 v96, v96, v88, v92
    v_fma_f32 v97, v97, v89, v93
    v_fma_f32 v98, v98, v90, v94
    v_fma_f32 v99, v99, v91, v95
    v_cvt_pk_f16_f32 v82, v96, v97
    v_cvt_pk_f16_f32 v83, v98, v99
    ds_write_b64 v6, v[82:83] offset:5120
    s_waitcnt vmcnt(2)
    v_lshlrev_b32 v96, 16, v84
    v_and_b32 v97, 0xffff0000, v84
    v_lshlrev_b32 v98, 16, v85
    v_and_b32 v99, 0xffff0000, v85
    v_fma_f32 v96, v96, v88, v92
    v_fma_f32 v97, v97, v89, v93
    v_fma_f32 v98, v98, v90, v94
    v_fma_f32 v99, v99, v91, v95
    v_cvt_pk_f16_f32 v84, v96, v97
    v_cvt_pk_f16_f32 v85, v98, v99
    ds_write_b64 v6, v[84:85] offset:10240
    s_waitcnt vmcnt(1)
    v_lshlrev_b32 v96, 16, v86
    v_and_b32 v97, 0xffff0000, v86
    v_lshlrev_b32 v98, 16, v87
    v_and_b32 v99, 0xffff0000, v87
    v_fma_f32 v96, v96, v88, v92
    v_fma_f32 v97, v97, v89, v93
    v_fma_f32 v98, v98, v90, v94
    v_fma_f32 v99, v99, v91, v95
    v_cvt_pk_f16_f32 v86, v96, v97
    v_cvt_pk_f16_f32 v87, v98, v99
    ds_write_b64 v6, v[86:87] offset:15360
    s_waitcnt lgkmcnt(0)
    s_barrier
    ds_read_b64_tr_b16 v[16:17], v9 offset:0
    ds_read_b64_tr_b16 v[18:19], v9 offset:2560
    ds_read_b64_tr_b16 v[20:21], v9 offset:32
    ds_read_b64_tr_b16 v[22:23], v9 offset:2592
    ds_read_b64_tr_b16 v[24:25], v9 offset:64
    ds_read_b64_tr_b16 v[26:27], v9 offset:2624
    ds_read_b64_tr_b16 v[28:29], v9 offset:96
    ds_read_b64_tr_b16 v[30:31], v9 offset:2656
    s_waitcnt lgkmcnt(6)
    v_mfma_f32_16x16x32_f16 v[104:107], v[16:19], v[32:35], 0
    v_mfma_f32_16x16x32_f16 v[16:19], v[16:19], v[36:39], 0
    s_waitcnt lgkmcnt(4)
    v_mfma_f32_16x16x32_f16 v[108:111], v[20:23], v[32:35], 0
    v_mfma_f32_16x16x32_f16 v[20:23], v[20:23], v[36:39], 0
    s_waitcnt lgkmcnt(2)
    v_mfma_f32_16x16x32_f16 v[112:115], v[24:27], v[32:35], 0
    v_mfma_f32_16x16x32_f16 v[24:27], v[24:27], v[36:39], 0
    s_waitcnt lgkmcnt(0)
    v_mfma_f32_16x16x32_f16 v[116:119], v[28:31], v[32:35], 0
    v_mfma_f32_16x16x32_f16 v[28:31], v[28:31], v[36:39], 0
    ds_read_b128 v[72:75], v8 offset:53248
    ds_read_b128 v[76:79], v8 offset:54272
    ds_read_b128 v[80:83], v8 offset:55296
    ds_read_b128 v[84:87], v8 offset:56320
    ds_read_b128 v[88:91], v8 offset:57344
    ds_read_b128 v[92:95], v8 offset:58368
    ds_read_b128 v[96:99], v8 offset:59392
    ds_read_b128 v[100:103], v8 offset:60416
    v_mul_f32 v10, v104, v40
    v_mul_f32 v12, v104, v44
    v_mul_f32 v11, v105, v41
    v_mul_f32 v13, v105, v45
    v_fma_f32 v10, -v16, v44, v10
    v_fma_f32 v12, v16, v40, v12
    v_fma_f32 v11, -v17, v45, v11
    v_fma_f32 v13, v17, v41, v13
    v_cvt_pk_f16_f32 v120, v10, v11
    v_cvt_pk_f16_f32 v32, v12, v13
    v_cvt_pk_f16_f32 v16, -v12, -v13
    v_mul_f32 v10, v106, v42
    v_mul_f32 v12, v106, v46
    v_mul_f32 v11, v107, v43
    v_mul_f32 v13, v107, v47
    v_fma_f32 v10, -v18, v46, v10
    v_fma_f32 v12, v18, v42, v12
    v_fma_f32 v11, -v19, v47, v11
    v_fma_f32 v13, v19, v43, v13
    v_cvt_pk_f16_f32 v121, v10, v11
    v_cvt_pk_f16_f32 v33, v12, v13
    v_cvt_pk_f16_f32 v17, -v12, -v13
    v_mul_f32 v10, v108, v48
    v_mul_f32 v12, v108, v52
    v_mul_f32 v11, v109, v49
    v_mul_f32 v13, v109, v53
    v_fma_f32 v10, -v20, v52, v10
    v_fma_f32 v12, v20, v48, v12
    v_fma_f32 v11, -v21, v53, v11
    v_fma_f32 v13, v21, v49, v13
    v_cvt_pk_f16_f32 v122, v10, v11
    v_cvt_pk_f16_f32 v34, v12, v13
    v_cvt_pk_f16_f32 v18, -v12, -v13
    v_mul_f32 v10, v110, v50
    v_mul_f32 v12, v110, v54
    v_mul_f32 v11, v111, v51
    v_mul_f32 v13, v111, v55
    v_fma_f32 v10, -v22, v54, v10
    v_fma_f32 v12, v22, v50, v12
    v_fma_f32 v11, -v23, v55, v11
    v_fma_f32 v13, v23, v51, v13
    v_cvt_pk_f16_f32 v123, v10, v11
    v_cvt_pk_f16_f32 v35, v12, v13
    v_cvt_pk_f16_f32 v19, -v12, -v13
    v_mul_f32 v10, v112, v56
    v_mul_f32 v12, v112, v60
    v_mul_f32 v11, v113, v57
    v_mul_f32 v13, v113, v61
    v_fma_f32 v10, -v24, v60, v10
    v_fma_f32 v12, v24, v56, v12
    v_fma_f32 v11, -v25, v61, v11
    v_fma_f32 v13, v25, v57, v13
    v_cvt_pk_f16_f32 v124, v10, v11
    v_cvt_pk_f16_f32 v36, v12, v13
    v_cvt_pk_f16_f32 v20, -v12, -v13
    v_mul_f32 v10, v114, v58
    v_mul_f32 v12, v114, v62
    v_mul_f32 v11, v115, v59
    v_mul_f32 v13, v115, v63
    v_fma_f32 v10, -v26, v62, v10
    v_fma_f32 v12, v26, v58, v12
    v_fma_f32 v11, -v27, v63, v11
    v_fma_f32 v13, v27, v59, v13
    v_cvt_pk_f16_f32 v125, v10, v11
    v_cvt_pk_f16_f32 v37, v12, v13
    v_cvt_pk_f16_f32 v21, -v12, -v13
    v_mul_f32 v10, v116, v64
    v_mul_f32 v12, v116, v68
    v_mul_f32 v11, v117, v65
    v_mul_f32 v13, v117, v69
    v_fma_f32 v10, -v28, v68, v10
    v_fma_f32 v12, v28, v64, v12
    v_fma_f32 v11, -v29, v69, v11
    v_fma_f32 v13, v29, v65, v13
    v_cvt_pk_f16_f32 v126, v10, v11
    v_cvt_pk_f16_f32 v38, v12, v13
    v_cvt_pk_f16_f32 v22, -v12, -v13
    v_mul_f32 v10, v118, v66
    v_mul_f32 v12, v118, v70
    v_mul_f32 v11, v119, v67
    v_mul_f32 v13, v119, v71
    v_fma_f32 v10, -v30, v70, v10
    v_fma_f32 v12, v30, v66, v12
    v_fma_f32 v11, -v31, v71, v11
    v_fma_f32 v13, v31, v67, v13
    v_cvt_pk_f16_f32 v127, v10, v11
    v_cvt_pk_f16_f32 v39, v12, v13
    v_cvt_pk_f16_f32 v23, -v12, -v13
    s_waitcnt lgkmcnt(0)
    v_mfma_f32_16x16x32_f16 v[40:43], v[120:123], v[72:75], 0
    v_add_f32 v4, v104, v106
    v_add_f32 v5, v105, v107
    v_mfma_f32_16x16x32_f16 v[48:51], v[120:123], v[76:79], 0
    v_add_f32 v4, v4, v108
    v_add_f32 v5, v5, v109
    v_mfma_f32_16x16x32_f16 v[44:47], v[120:123], v[80:83], 0
    v_add_f32 v4, v4, v110
    v_add_f32 v5, v5, v111
    v_mfma_f32_16x16x32_f16 v[52:55], v[120:123], v[84:87], 0
    v_add_f32 v4, v4, v112
    v_add_f32 v5, v5, v113
    v_mfma_f32_16x16x32_f16 v[40:43], v[16:19], v[76:79], v[40:43]
    v_add_f32 v4, v4, v114
    v_add_f32 v5, v5, v115
    v_mfma_f32_16x16x32_f16 v[48:51], v[32:35], v[72:75], v[48:51]
    v_add_f32 v4, v4, v116
    v_add_f32 v5, v5, v117
    v_mfma_f32_16x16x32_f16 v[44:47], v[16:19], v[84:87], v[44:47]
    v_add_f32 v4, v4, v118
    v_add_f32 v5, v5, v119
    v_mfma_f32_16x16x32_f16 v[52:55], v[32:35], v[80:83], v[52:55]
    v_sub_f32 v4, v4, v5
    v_and_b32 v6, 15, v0
    v_mfma_f32_16x16x32_f16 v[40:43], v[124:127], v[88:91], v[40:43]
    v_mul_u32_u24 v6, 144, v6
    v_lshrrev_b32 v7, 4, v0
    v_mfma_f32_16x16x32_f16 v[48:51], v[124:127], v[92:95], v[48:51]
    v_lshl_add_u32 v6, v7, 4, v6
    v_readlane_b32 s44, v4, 0
    v_mfma_f32_16x16x32_f16 v[44:47], v[124:127], v[96:99], v[44:47]
    v_readlane_b32 s45, v4, 16
    v_readlane_b32 s46, v4, 32
    v_mfma_f32_16x16x32_f16 v[52:55], v[124:127], v[100:103], v[52:55]
    v_readlane_b32 s47, v4, 48
    s_mul_i32 s16, s27, 4608
    v_mfma_f32_16x16x32_f16 v[40:43], v[20:23], v[92:95], v[40:43]
    s_lshl_b32 s17, s20, 6
    s_add_u32 s16, s16, s17
    v_mfma_f32_16x16x32_f16 v[48:51], v[36:39], v[88:91], v[48:51]
    v_add_u32 v6, s16, v6
    v_lshrrev_b32 v7, 5, v1
    v_mfma_f32_16x16x32_f16 v[44:47], v[20:23], v[100:103], v[44:47]
    v_mul_u32_u24 v7, 144, v7
    v_and_b32 v9, 31, v1
    v_mfma_f32_16x16x32_f16 v[52:55], v[36:39], v[96:99], v[52:55]
    v_lshl_add_u32 v7, v9, 2, v7
    v_lshrrev_b32 v9, 2, v1
    v_lshlrev_b32 v9, 14, v9
    v_and_b32 v2, 3, v1
    v_lshl_add_u32 v9, v2, 4, v9
    v_mov_b32 v4, s44
    v_add_f32 v4, s45, v4
    v_add_f32 v4, s46, v4
    v_add_f32 v4, s47, v4
    v_mul_f32 v4, 1031798784, v4
    s_lshl_b32 s16, s2, 6
    s_add_u32 s17, s16, 2097152
    s_add_u32 s10, s32, 4194304
    s_add_u32 s8, s38, s10
    s_addc_u32 s9, s39, 0
    s_mov_b32 s10, 4194304
    s_mov_b32 s11, 0x20000
    s_xor_b32 s18, s20, 1
    s_mov_b32 s19, 0
    v_cndmask_b32 v48, v48, v4, s[18:19]
    v_cvt_pk_f16_f32 v32, v40, v48
    v_cvt_pk_f16_f32 v33, v41, v49
    v_cvt_pk_f16_f32 v34, v42, v50
    v_cvt_pk_f16_f32 v35, v43, v51
    v_cvt_pk_f16_f32 v36, v44, v52
    v_cvt_pk_f16_f32 v37, v45, v53
    v_cvt_pk_f16_f32 v38, v46, v54
    v_cvt_pk_f16_f32 v39, v47, v55
    ds_write_b128 v6, v[32:35] offset:28672
    ds_write_b128 v6, v[36:39] offset:30976
    s_waitcnt lgkmcnt(0)
    s_barrier
    ds_read_b32 v56, v7 offset:28672
    ds_read_b32 v57, v7 offset:33280
    ds_read_b32 v58, v7 offset:37888
    ds_read_b32 v59, v7 offset:42496
    ds_read_b32 v60, v7 offset:30976
    ds_read_b32 v61, v7 offset:35584
    ds_read_b32 v62, v7 offset:40192
    ds_read_b32 v63, v7 offset:44800
    s_waitcnt lgkmcnt(4)
    buffer_store_dwordx4 v[56:59], v9, s[8:11], s16 offen sc1
    s_waitcnt lgkmcnt(0)
    buffer_store_dwordx4 v[60:63], v9, s[8:11], s17 offen sc1
    s_setprio 0
    s_load_dwordx2 s[40:41], s[0:1], 0
    v_lshlrev_b32 v8, 4, v0
    v_lshrrev_b32 v1, 4, v0
    v_xor_b32 v1, v1, v0
    v_and_b32 v1, 3, v1
    v_and_b32 v2, 0xfc, v0
    v_or_b32 v1, v1, v2
    v_lshlrev_b32 v1, 4, v1
    s_and_b32 s20, s3, 1
    s_lshr_b32 s27, s3, 1
    s_lshl_b32 s16, s2, 2
    s_add_u32 s16, s16, s27
    s_sub_u32 s19, 2048, s16
    s_cmp_eq_u32 s16, 0
    s_cselect_b32 s19, 1024, s19
    s_cmp_eq_u32 s20, 0
    s_cselect_b32 s19, s16, s19
    s_lshl_b32 s21, s19, 11
    s_lshl_b32 s17, s2, 14
    s_lshl_b32 s18, s3, 11
    s_add_u32 s17, s17, s18
    s_mov_b32 m0, s18
    v_and_b32 v4, 15, v0
    v_lshrrev_b32 v5, 4, v0
    s_lshl_b32 s24, s20, 4
    v_add_u32 v6, s24, v4
    v_xor_b32 v9, 16, v6
    v_cvt_f32_u32 v6, v6
    v_cvt_f32_u32 v9, v9
    v_lshlrev_b32 v7, 2, v5
    v_cvt_f32_u32 v7, v7
    v_mul_f32 v24, 3170893824, v6
    v_mul_f32 v25, v24, v7
    v_mov_b32 v20, v25
    v_fmamk_f32 v21, v24, 1065353216, v25
    v_fmamk_f32 v22, v24, 1073741824, v25
    v_fmamk_f32 v23, v24, 1077936128, v25
    v_cos_f32 v16, v20
    v_sin_f32 v20, v20
    v_cos_f32 v17, v21
    v_sin_f32 v21, v21
    v_cos_f32 v18, v22
    v_sin_f32 v22, v22
    v_cos_f32 v19, v23
    v_sin_f32 v23, v23
    s_nop 0
    v_cvt_pk_f16_f32 v32, v16, v17
    v_cvt_pk_f16_f32 v36, v20, v21
    v_cvt_pk_f16_f32 v33, v18, v19
    v_cvt_pk_f16_f32 v37, v22, v23
    v_fmamk_f32 v20, v24, 1098907648, v25
    v_fmamk_f32 v21, v24, 1099431936, v25
    v_fmamk_f32 v22, v24, 1099956224, v25
    v_fmamk_f32 v23, v24, 1100480512, v25
    v_cos_f32 v16, v20
    v_sin_f32 v20, v20
    v_cos_f32 v17, v21
    v_sin_f32 v21, v21
    v_cos_f32 v18, v22
    v_sin_f32 v22, v22
    v_cos_f32 v19, v23
    v_sin_f32 v23, v23
    s_nop 0
    v_cvt_pk_f16_f32 v34, v16, v17
    v_cvt_pk_f16_f32 v38, v20, v21
    v_cvt_pk_f16_f32 v35, v18, v19
    v_cvt_pk_f16_f32 v39, v22, v23
    v_mul_f32 v16, 3128950784, v6
    v_mul_f32 v17, v16, v7
    v_mov_b32 v52, v17
    v_fmamk_f32 v53, v16, 1065353216, v17
    v_fmamk_f32 v54, v16, 1073741824, v17
    v_fmamk_f32 v55, v16, 1077936128, v17
    v_fmamk_f32 v60, v16, 1098907648, v17
    v_fmamk_f32 v61, v16, 1099431936, v17
    v_fmamk_f32 v62, v16, 1099956224, v17
    v_fmamk_f32 v63, v16, 1100480512, v17
    v_cos_f32 v48, v52
    v_sin_f32 v52, v52
    v_cos_f32 v49, v53
    v_sin_f32 v53, v53
    v_cos_f32 v50, v54
    v_sin_f32 v54, v54
    v_cos_f32 v51, v55
    v_sin_f32 v55, v55
    v_cos_f32 v56, v60
    v_sin_f32 v60, v60
    v_cos_f32 v57, v61
    v_sin_f32 v61, v61
    v_cos_f32 v58, v62
    v_sin_f32 v62, v62
    v_cos_f32 v59, v63
    v_sin_f32 v63, v63
    v_mov_b32 v200, s79
    v_mov_b32 v201, 1
    s_cmp_eq_u32 s3, 4
    s_cselect_b32 s80, 512, 1
    s_cselect_b32 s81, 0, 4
    v_add_u32 v202, s81, v200
    s_lshl_b32 s86, s33, 14
    s_add_u32 s86, s86, 46170112
    s_add_u32 s84, s38, s86
    s_addc_u32 s85, s39, 0
    s_mov_b32 s86, 16384
    s_mov_b32 s87, 0x20000
    v_mov_b32 v203, 0x10000
    v_mov_b32 v206, 0x10000
    s_lshr_b32 s82, s2, 4
    s_lshl_b32 s82, s82, 7
    v_writelane_b32 v203, s82, 0
    s_and_b32 s82, s2, 15
    s_lshl_b32 s82, s82, 7
    v_writelane_b32 v206, s82, 0
    v_lshlrev_b32 v204, 7, v0
    v_and_b32 v205, 48, v0
    v_lshl_add_u32 v204, v205, 12, v204
    s_mov_b32 s82, 12288
    s_mov_b32 s83, 14336
    s_mov_b32 s88, 0x40000
    s_waitcnt vmcnt(0) lgkmcnt(0)
    ds_add_u32 v200, v201 offset:40
    s_cmp_ge_u32 s3, 2
    s_cbranch_scc1 gsp_15
    s_cmp_lg_u32 s33, 0
    s_cbranch_scc1 gsp_15
    s_add_u32 s84, s68, 0
    s_addc_u32 s85, s69, 0
    s_mov_b32 s86, 7340032
    s_mov_b32 s87, 0x20000
    s_mul_i32 s82, s2, 2
    s_add_u32 s82, s82, s3
    s_mul_i32 s82, s82, 7168
    v_lshlrev_b32 v203, 7, v0
    buffer_load_dword v208, v203, s[84:87], s82 offen
gsp_15:
    ds_read_b32 v205, v202 offset:40
    s_sub_u32 s88, s88, 1
    s_waitcnt lgkmcnt(0)
    v_readfirstlane_b32 s89, v205
    s_cmp_eq_u32 s88, 0
    s_cbranch_scc1 gw_16
    s_cmp_ge_u32 s89, s80
    s_cbranch_scc1 gw_16
    s_sleep 1
    s_branch gsp_15
gw_16:
    s_cmp_lg_u32 s3, 4
    s_cbranch_scc1 gok_17
    s_mov_b32 s88, 0x4000
    v_mov_b32 v205, 1
    buffer_atomic_add v205, v203, s[84:87], s82 offen sc0 sc1
    s_waitcnt vmcnt(0)
    v_readfirstlane_b32 s89, v205
    s_cmp_lg_u32 s89, 15
    s_cbranch_scc1 gpo_18
    buffer_atomic_add v201, v204, s[84:87], s83 offen sc1
gpo_18:
    v_mov_b32 v205, 0
    buffer_atomic_add v205, v206, s[84:87], s83 offen sc0 sc1
    s_sub_u32 s88, s88, 1
    s_waitcnt vmcnt(0)
    v_readfirstlane_b32 s89, v205
    s_cmp_eq_u32 s88, 0
    s_cbranch_scc1 ggo_19
    s_cmp_lt_u32 s89, 16
    s_cbranch_scc1 gpo_18
ggo_19:
    ds_write_b32 v200, v200 offset:44
gok_17:
    s_setprio 2
    s_add_u32 s6, s32, 4194304
    s_add_u32 s4, s38, s6
    s_addc_u32 s5, s39, 0
    s_mov_b32 s6, 4194304
    s_mov_b32 s7, 0x20000
    buffer_load_dwordx4 v1, s[4:7], s17 offen lds
    buffer_load_dwordx4 v1, s[4:7], s17 offen offset:1024 lds
    v_mul_f32 v24, 3170893824, v9
    v_mul_f32 v25, v24, v7
    v_mov_b32 v20, v25
    v_fmamk_f32 v21, v24, 1065353216, v25
    v_fmamk_f32 v22, v24, 1073741824, v25
    v_fmamk_f32 v23, v24, 1077936128, v25
    v_cos_f32 v16, v20
    v_sin_f32 v20, v20
    v_cos_f32 v17, v21
    v_sin_f32 v21, v21
    v_cos_f32 v18, v22
    v_sin_f32 v22, v22
    v_cos_f32 v19, v23
    v_sin_f32 v23, v23
    s_nop 0
    v_cvt_pk_f16_f32 v40, v16, v17
    v_cvt_pk_f16_f32 v44, v20, v21
    v_cvt_pk_f16_f32 v41, v18, v19
    v_cvt_pk_f16_f32 v45, v22, v23
    v_fmamk_f32 v20, v24, 1098907648, v25
    v_fmamk_f32 v21, v24, 1099431936, v25
    v_fmamk_f32 v22, v24, 1099956224, v25
    v_fmamk_f32 v23, v24, 1100480512, v25
    v_cos_f32 v16, v20
    v_sin_f32 v20, v20
    v_cos_f32 v17, v21
    v_sin_f32 v21, v21
    v_cos_f32 v18, v22
    v_sin_f32 v22, v22
    v_cos_f32 v19, v23
    v_sin_f32 v23, v23
    s_nop 0
    v_cvt_pk_f16_f32 v42, v16, v17
    v_cvt_pk_f16_f32 v46, v20, v21
    v_cvt_pk_f16_f32 v43, v18, v19
    v_cvt_pk_f16_f32 v47, v22, v23
    s_add_u32 s24, s38, 41943040
    s_addc_u32 s25, s39, 0
    s_cmp_eq_u32 s33, 0
    s_cselect_b32 s8, s40, s24
    s_cselect_b32 s9, s41, s25
    s_mov_b32 s10, 4194304
    s_mov_b32 s11, 0x20000
    v_lshrrev_b32 v10, 2, v4
    v_xor_b32 v10, s27, v10
    v_lshlrev_b32 v10, 4, v10
    v_lshl_add_u32 v10, v4, 6, v10
    v_lshl_add_u32 v10, v5, 11, v10
    s_mov_b32 s22, 0x05040100
    s_mov_b32 s23, 0x07060302
    v_mul_u32_u24 v6, 144, v4
    v_lshl_add_u32 v6, v5, 4, v6
    s_mul_i32 s24, s27, 9216
    s_lshl_b32 s26, s20, 6
    s_add_u32 s24, s24, s26
    s_mul_i32 s26, s20, 2304
    s_add_u32 s25, s24, s26
    s_sub_u32 s24, s24, s26
    s_add_u32 s24, s24, 2304
    v_add_u32 v7, s24, v6
    v_add_u32 v6, s25, v6
    v_lshrrev_b32 v9, 2, v0
    v_mul_u32_u24 v9, 144, v9
    v_and_b32 v11, 3, v0
    v_lshl_add_u32 v9, v11, 5, v9
    s_mul_i32 s24, s3, 4608
    v_add_u32 v9, s24, v9
    s_add_u32 s6, s32, 8388608
    s_add_u32 s4, s38, s6
    s_addc_u32 s5, s39, 0
    s_mov_b32 s6, 4194304
    s_mov_b32 s7, 0x20000
    s_add_u32 s14, s32, 12582912
    s_add_u32 s12, s38, s14
    s_addc_u32 s13, s39, 0
    s_mov_b32 s14, 4194304
    s_mov_b32 s15, 0x20000
    s_waitcnt vmcnt(0)
    s_barrier
    ds_read_b128 v[16:19], v10 offset:0
    ds_read_b128 v[20:23], v10 offset:8192
    ds_read_b128 v[24:27], v10 offset:1024
    ds_read_b128 v[28:31], v10 offset:9216
    buffer_load_dwordx4 v[112:115], v8, s[8:11], s21 offen offset:0
    buffer_load_dwordx4 v[116:119], v8, s[8:11], s21 offen offset:1024
    s_waitcnt lgkmcnt(2)
    v_perm_b32 v64, v17, v16, s22
    v_perm_b32 v65, v19, v18, s22
    v_perm_b32 v66, v21, v20, s22
    v_perm_b32 v67, v23, v22, s22
    v_perm_b32 v72, v17, v16, s23
    v_perm_b32 v73, v19, v18, s23
    v_perm_b32 v74, v21, v20, s23
    v_perm_b32 v75, v23, v22, s23
    v_mfma_f32_16x16x32_f16 v[80:83], v[64:67], v[32:35], 0
    v_mfma_f32_16x16x32_f16 v[88:91], v[64:67], v[36:39], 0
    v_mfma_f32_16x16x32_f16 v[96:99], v[72:75], v[32:35], 0
    v_mfma_f32_16x16x32_f16 v[104:107], v[72:75], v[36:39], 0
    s_waitcnt lgkmcnt(0)
    v_perm_b32 v68, v25, v24, s22
    v_perm_b32 v69, v27, v26, s22
    v_perm_b32 v70, v29, v28, s22
    v_perm_b32 v71, v31, v30, s22
    v_perm_b32 v76, v25, v24, s23
    v_perm_b32 v77, v27, v26, s23
    v_perm_b32 v78, v29, v28, s23
    v_perm_b32 v79, v31, v30, s23
    v_mfma_f32_16x16x32_f16 v[84:87], v[68:71], v[32:35], 0
    v_mfma_f32_16x16x32_f16 v[92:95], v[68:71], v[36:39], 0
    v_mfma_f32_16x16x32_f16 v[100:103], v[76:79], v[32:35], 0
    v_mfma_f32_16x16x32_f16 v[108:111], v[76:79], v[36:39], 0
    v_mul_f32 v16, v80, v52
    v_mul_f32 v80, v80, v48
    v_fma_f32 v80, -v88, v52, v80
    v_fma_f32 v88, v88, v48, v16
    v_mul_f32 v17, v104, v52
    v_mul_f32 v104, v104, v48
    v_fma_f32 v104, v96, v52, v104
    v_fma_f32 v96, v96, v48, -v17
    v_mul_f32 v18, v81, v53
    v_mul_f32 v81, v81, v49
    v_fma_f32 v81, -v89, v53, v81
    v_fma_f32 v89, v89, v49, v18
    v_mul_f32 v19, v105, v53
    v_mul_f32 v105, v105, v49
    v_fma_f32 v105, v97, v53, v105
    v_fma_f32 v97, v97, v49, -v19
    v_mul_f32 v20, v82, v54
    v_mul_f32 v82, v82, v50
    v_fma_f32 v82, -v90, v54, v82
    v_fma_f32 v90, v90, v50, v20
    v_mul_f32 v21, v106, v54
    v_mul_f32 v106, v106, v50
    v_fma_f32 v106, v98, v54, v106
    v_fma_f32 v98, v98, v50, -v21
    v_mul_f32 v22, v83, v55
    v_mul_f32 v83, v83, v51
    v_fma_f32 v83, -v91, v55, v83
    v_fma_f32 v91, v91, v51, v22
    v_mul_f32 v23, v107, v55
    v_mul_f32 v107, v107, v51
    v_fma_f32 v107, v99, v55, v107
    v_fma_f32 v99, v99, v51, -v23
    s_nop 1
    v_mul_f32 v24, v84, v60
    v_mul_f32 v84, v84, v56
    v_fma_f32 v84, -v92, v60, v84
    v_fma_f32 v92, v92, v56, v24
    v_mul_f32 v25, v108, v60
    v_mul_f32 v108, v108, v56
    v_fma_f32 v108, v100, v60, v108
    v_fma_f32 v100, v100, v56, -v25
    v_mul_f32 v26, v85, v61
    v_mul_f32 v85, v85, v57
    v_fma_f32 v85, -v93, v61, v85
    v_fma_f32 v93, v93, v57, v26
    v_mul_f32 v27, v109, v61
    v_mul_f32 v109, v109, v57
    v_fma_f32 v109, v101, v61, v109
    v_fma_f32 v101, v101, v57, -v27
    v_mul_f32 v28, v86, v62
    v_mul_f32 v86, v86, v58
    v_fma_f32 v86, -v94, v62, v86
    v_fma_f32 v94, v94, v58, v28
    v_mul_f32 v29, v110, v62
    v_mul_f32 v110, v110, v58
    v_fma_f32 v110, v102, v62, v110
    v_fma_f32 v102, v102, v58, -v29
    v_mul_f32 v30, v87, v63
    v_mul_f32 v87, v87, v59
    v_fma_f32 v87, -v95, v63, v87
    v_fma_f32 v95, v95, v59, v30
    v_mul_f32 v31, v111, v63
    v_mul_f32 v111, v111, v59
    v_fma_f32 v111, v103, v63, v111
    v_fma_f32 v103, v103, v59, -v31
    s_cmp_eq_u32 s16, 0
    s_cbranch_scc1 t0_20
    v_sub_f32 v16, v80, v104
    v_add_f32 v18, v80, v104
    v_add_f32 v20, v88, v96
    v_sub_f32 v22, v96, v88
    v_sub_f32 v17, v81, v105
    v_add_f32 v19, v81, v105
    v_add_f32 v21, v89, v97
    v_sub_f32 v23, v97, v89
    v_cvt_pk_f16_f32 v64, v16, v17
    v_cvt_pk_f16_f32 v72, v18, v19
    v_cvt_pk_f16_f32 v68, -v20, -v21
    v_cvt_pk_f16_f32 v76, v22, v23
    v_sub_f32 v16, v82, v106
    v_add_f32 v18, v82, v106
    v_add_f32 v20, v90, v98
    v_sub_f32 v22, v98, v90
    v_sub_f32 v17, v83, v107
    v_add_f32 v19, v83, v107
    v_add_f32 v21, v91, v99
    v_sub_f32 v23, v99, v91
    v_cvt_pk_f16_f32 v65, v16, v17
    v_cvt_pk_f16_f32 v73, v18, v19
    v_cvt_pk_f16_f32 v69, -v20, -v21
    v_cvt_pk_f16_f32 v77, v22, v23
    v_sub_f32 v16, v84, v108
    v_add_f32 v18, v84, v108
    v_add_f32 v20, v92, v100
    v_sub_f32 v22, v100, v92
    v_sub_f32 v17, v85, v109
    v_add_f32 v19, v85, v109
    v_add_f32 v21, v93, v101
    v_sub_f32 v23, v101, v93
    v_cvt_pk_f16_f32 v66, v16, v17
    v_cvt_pk_f16_f32 v74, v18, v19
    v_cvt_pk_f16_f32 v70, -v20, -v21
    v_cvt_pk_f16_f32 v78, v22, v23
    v_sub_f32 v16, v86, v110
    v_add_f32 v18, v86, v110
    v_add_f32 v20, v94, v102
    v_sub_f32 v22, v102, v94
    v_sub_f32 v17, v87, v111
    v_add_f32 v19, v87, v111
    v_add_f32 v21, v95, v103
    v_sub_f32 v23, v103, v95
    v_cvt_pk_f16_f32 v67, v16, v17
    v_cvt_pk_f16_f32 v75, v18, v19
    v_cvt_pk_f16_f32 v71, -v20, -v21
    v_cvt_pk_f16_f32 v79, v22, v23
    s_branch tj_21
t0_20:
    v_cvt_pk_f16_f32 v64, v80, v81
    v_cvt_pk_f16_f32 v72, v96, v97
    v_cvt_pk_f16_f32 v68, -v88, -v89
    v_cvt_pk_f16_f32 v76, -v104, -v105
    v_cvt_pk_f16_f32 v65, v82, v83
    v_cvt_pk_f16_f32 v73, v98, v99
    v_cvt_pk_f16_f32 v69, -v90, -v91
    v_cvt_pk_f16_f32 v77, -v106, -v107
    v_cvt_pk_f16_f32 v66, v84, v85
    v_cvt_pk_f16_f32 v74, v100, v101
    v_cvt_pk_f16_f32 v70, -v92, -v93
    v_cvt_pk_f16_f32 v78, -v108, -v109
    v_cvt_pk_f16_f32 v67, v86, v87
    v_cvt_pk_f16_f32 v75, v102, v103
    v_cvt_pk_f16_f32 v71, -v94, -v95
    v_cvt_pk_f16_f32 v79, -v110, -v111
tj_21:
    v_mfma_f32_16x16x32_f16 v[80:83], v[64:67], v[32:35], 0
    v_mfma_f32_16x16x32_f16 v[84:87], v[64:67], v[40:43], 0
    v_mfma_f32_16x16x32_f16 v[88:91], v[72:75], v[32:35], 0
    v_mfma_f32_16x16x32_f16 v[92:95], v[72:75], v[40:43], 0
    v_mfma_f32_16x16x32_f16 v[80:83], v[68:71], v[36:39], v[80:83]
    v_mfma_f32_16x16x32_f16 v[84:87], v[68:71], v[44:47], v[84:87]
    v_mfma_f32_16x16x32_f16 v[88:91], v[76:79], v[36:39], v[88:91]
    v_mfma_f32_16x16x32_f16 v[92:95], v[76:79], v[44:47], v[92:95]
    s_nop 4
    ds_write_b128 v6, v[80:83] offset:16384
    ds_write_b128 v7, v[84:87] offset:16384
    ds_write_b128 v6, v[88:91] offset:20992
    ds_write_b128 v7, v[92:95] offset:20992
    v_mov_b32 v4, 16.0
    s_waitcnt lgkmcnt(0)
    s_barrier
    ds_read_b128 v[32:35], v9 offset:16384
    ds_read_b128 v[36:39], v9 offset:16400
    ds_read_b128 v[40:43], v9 offset:18688
    ds_read_b128 v[44:47], v9 offset:18704
    s_waitcnt vmcnt(0)
    v_lshlrev_b32 v16, 16, v112
    v_and_b32 v17, 0xffff0000, v112
    v_lshlrev_b32 v18, 16, v113
    v_and_b32 v19, 0xffff0000, v113
    v_lshlrev_b32 v20, 16, v114
    v_and_b32 v21, 0xffff0000, v114
    v_lshlrev_b32 v22, 16, v115
    v_and_b32 v23, 0xffff0000, v115
    v_lshlrev_b32 v24, 16, v116
    v_and_b32 v25, 0xffff0000, v116
    v_lshlrev_b32 v26, 16, v117
    v_and_b32 v27, 0xffff0000, v117
    v_lshlrev_b32 v28, 16, v118
    v_and_b32 v29, 0xffff0000, v118
    v_lshlrev_b32 v30, 16, v119
    v_and_b32 v31, 0xffff0000, v119
    s_waitcnt lgkmcnt(2)
    v_fma_f32 v32, v32, v4, v16
    v_fma_f32 v33, v33, v4, v17
    v_fma_f32 v34, v34, v4, v18
    v_fma_f32 v35, v35, v4, v19
    v_fma_f32 v36, v36, v4, v20
    v_fma_f32 v37, v37, v4, v21
    v_fma_f32 v38, v38, v4, v22
    v_fma_f32 v39, v39, v4, v23
    v_cvt_pk_bf16_f32 v112, v32, v33
    v_cvt_pk_bf16_f32 v113, v34, v35
    v_cvt_pk_bf16_f32 v114, v36, v37
    v_cvt_pk_bf16_f32 v115, v38, v39
    buffer_store_dwordx4 v[112:115], v8, s[4:7], s21 offen offset:0 sc1
    s_waitcnt lgkmcnt(0)
    v_fma_f32 v40, v40, v4, v24
    v_fma_f32 v41, v41, v4, v25
    v_fma_f32 v42, v42, v4, v26
    v_fma_f32 v43, v43, v4, v27
    v_fma_f32 v44, v44, v4, v28
    v_fma_f32 v45, v45, v4, v29
    v_fma_f32 v46, v46, v4, v30
    v_fma_f32 v47, v47, v4, v31
    v_cvt_pk_bf16_f32 v116, v40, v41
    v_cvt_pk_bf16_f32 v117, v42, v43
    v_cvt_pk_bf16_f32 v118, v44, v45
    v_cvt_pk_bf16_f32 v119, v46, v47
    buffer_store_dwordx4 v[116:119], v8, s[4:7], s21 offen offset:1024 sc1
    v_lshlrev_b32 v16, 16, v112
    v_and_b32 v17, 0xffff0000, v112
    v_lshlrev_b32 v18, 16, v113
    v_and_b32 v19, 0xffff0000, v113
    v_lshlrev_b32 v20, 16, v114
    v_and_b32 v21, 0xffff0000, v114
    v_lshlrev_b32 v22, 16, v115
    v_and_b32 v23, 0xffff0000, v115
    v_lshlrev_b32 v24, 16, v116
    v_and_b32 v25, 0xffff0000, v116
    v_lshlrev_b32 v26, 16, v117
    v_and_b32 v27, 0xffff0000, v117
    v_lshlrev_b32 v28, 16, v118
    v_and_b32 v29, 0xffff0000, v118
    v_lshlrev_b32 v30, 16, v119
    v_and_b32 v31, 0xffff0000, v119
    v_add_f32 v4, v16, v17
    v_add_f32 v5, v18, v19
    v_add_f32 v4, v4, v20
    v_add_f32 v5, v5, v21
    v_add_f32 v4, v4, v22
    v_add_f32 v5, v5, v23
    v_add_f32 v4, v4, v24
    v_add_f32 v5, v5, v25
    v_add_f32 v4, v4, v26
    v_add_f32 v5, v5, v27
    v_add_f32 v4, v4, v28
    v_add_f32 v5, v5, v29
    v_add_f32 v4, v4, v30
    v_add_f32 v5, v5, v31
    v_add_f32 v4, v4, v5
    s_nop 1
    v_add_f32_dpp v4, v4, v4 quad_perm:[1,0,3,2] row_mask:0xf bank_mask:0xf
    s_nop 1
    v_add_f32_dpp v4, v4, v4 quad_perm:[2,3,0,1] row_mask:0xf bank_mask:0xf
    s_nop 1
    v_add_f32_dpp v4, v4, v4 row_half_mirror row_mask:0xf bank_mask:0xf
    s_nop 1
    v_add_f32_dpp v4, v4, v4 row_mirror row_mask:0xf bank_mask:0xf
    v_mov_b32 v5, v4
    s_nop 1
    v_permlane16_swap_b32 v4, v5
    s_nop 1
    v_add_f32 v4, v4, v5
    v_mov_b32 v5, v4
    s_nop 1
    v_permlane32_swap_b32 v4, v5
    s_nop 1
    v_add_f32 v4, v4, v5
    v_mul_f32 v4, 3128950784, v4
    v_add_f32 v16, v16, v4
    v_add_f32 v17, v17, v4
    v_add_f32 v18, v18, v4
    v_add_f32 v19, v19, v4
    v_add_f32 v20, v20, v4
    v_add_f32 v21, v21, v4
    v_add_f32 v22, v22, v4
    v_add_f32 v23, v23, v4
    v_add_f32 v24, v24, v4
    v_add_f32 v25, v25, v4
    v_add_f32 v26, v26, v4
    v_add_f32 v27, v27, v4
    v_add_f32 v28, v28, v4
    v_add_f32 v29, v29, v4
    v_add_f32 v30, v30, v4
    v_add_f32 v31, v31, v4
    v_mul_f32 v6, v16, v16
    v_mul_f32 v7, v17, v17
    v_fma_f32 v6, v18, v18, v6
    v_fma_f32 v7, v19, v19, v7
    v_fma_f32 v6, v20, v20, v6
    v_fma_f32 v7, v21, v21, v7
    v_fma_f32 v6, v22, v22, v6
    v_fma_f32 v7, v23, v23, v7
    v_fma_f32 v6, v24, v24, v6
    v_fma_f32 v7, v25, v25, v7
    v_fma_f32 v6, v26, v26, v6
    v_fma_f32 v7, v27, v27, v7
    v_fma_f32 v6, v28, v28, v6
    v_fma_f32 v7, v29, v29, v7
    v_fma_f32 v6, v30, v30, v6
    v_fma_f32 v7, v31, v31, v7
    v_add_f32 v6, v6, v7
    s_nop 1
    v_add_f32_dpp v6, v6, v6 quad_perm:[1,0,3,2] row_mask:0xf bank_mask:0xf
    s_nop 1
    v_add_f32_dpp v6, v6, v6 quad_perm:[2,3,0,1] row_mask:0xf bank_mask:0xf
    s_nop 1
    v_add_f32_dpp v6, v6, v6 row_half_mirror row_mask:0xf bank_mask:0xf
    s_nop 1
    v_add_f32_dpp v6, v6, v6 row_mirror row_mask:0xf bank_mask:0xf
    v_mov_b32 v7, v6
    s_nop 1
    v_permlane16_swap_b32 v6, v7
    s_nop 1
    v_add_f32 v6, v6, v7
    v_mov_b32 v7, v6
    s_nop 1
    v_permlane32_swap_b32 v6, v7
    s_nop 1
    v_add_f32 v6, v6, v7
    v_mov_b32 v5, 925353388
    v_fmamk_f32 v6, v6, 981467136, v5
    v_rsq_f32 v6, v6
    s_nop 0
    v_mul_f32 v16, v16, v6
    v_mul_f32 v17, v17, v6
    v_mul_f32 v18, v18, v6
    v_mul_f32 v19, v19, v6
    v_mul_f32 v20, v20, v6
    v_mul_f32 v21, v21, v6
    v_mul_f32 v22, v22, v6
    v_mul_f32 v23, v23, v6
    v_mul_f32 v24, v24, v6
    v_mul_f32 v25, v25, v6
    v_mul_f32 v26, v26, v6
    v_mul_f32 v27, v27, v6
    v_mul_f32 v28, v28, v6
    v_mul_f32 v29, v29, v6
    v_mul_f32 v30, v30, v6
    v_mul_f32 v31, v31, v6
    v_cvt_pk_bf16_f32 v32, v16, v17
    v_cvt_pk_bf16_f32 v33, v18, v19
    v_cvt_pk_bf16_f32 v34, v20, v21
    v_cvt_pk_bf16_f32 v35, v22, v23
    v_cvt_pk_bf16_f32 v36, v24, v25
    v_cvt_pk_bf16_f32 v37, v26, v27
    v_cvt_pk_bf16_f32 v38, v28, v29
    v_cvt_pk_bf16_f32 v39, v30, v31
    buffer_store_dwordx4 v[32:35], v8, s[12:15], s21 offen offset:0 sc1
    buffer_store_dwordx4 v[36:39], v8, s[12:15], s21 offen offset:1024 sc1
    s_setprio 0
    s_and_b32 s18, s2, 7
    s_lshr_b32 s19, s2, 3
    s_and_b32 s16, s18, 3
    s_lshl_b32 s16, s16, 2
    s_and_b32 s20, s19, 3
    s_add_u32 s16, s16, s20
    s_lshr_b32 s17, s18, 2
    s_lshl_b32 s17, s17, 3
    s_lshr_b32 s20, s19, 2
    s_add_u32 s17, s17, s20
    s_mov_b32 s31, 4294877184
    s_cmp_ge_u32 s3, 4
    s_cbranch_scc1 prod_6
    s_and_b32 s21, s3, 1
    s_lshr_b32 s22, s3, 1
    v_and_b32 v1, 15, v0
    v_lshrrev_b32 v2, 4, v0
    v_lshrrev_b32 v3, 1, v1
    v_xor_b32 v3, v2, v3
    v_lshlrev_b32 v3, 4, v3
    v_lshl_add_u32 v3, v1, 7, v3
    s_lshl_b32 s23, s21, 13
    v_add_u32 v4, s23, v3
    v_xor_b32 v5, 64, v4
    v_bfe_u32 v8, v0, 2, 2
    v_lshl_add_u32 v8, v2, 3, v8
    v_mul_u32_u24 v8, 448, v8
    v_and_b32 v9, 3, v0
    v_lshl_add_u32 v8, v9, 3, v8
    v_add_u32 v8, 16384, v8
    s_lshl_b32 s24, s22, 7
    v_add_u32 v8, s24, v8
    v_and_b32 v9, 1, v2
    v_lshlrev_b32 v9, 5, v9
    v_add_u32 v11, v8, v9
    v_sub_u32 v12, v8, v9
    v_add_u32 v9, 192, v11
    v_add_u32 v10, 96, v12
    s_cmp_eq_u32 s22, 0
    s_cselect_b64 s[26:27], -1, 0
    v_cndmask_b32 v13, v9, v10, s[26:27]
    v_mov_b32 v104, 0
    v_mov_b32 v105, 0
    v_mov_b32 v106, 0
    v_mov_b32 v107, 0
    v_mov_b32 v108, 0
    v_mov_b32 v109, 0
    v_mov_b32 v110, 0
    v_mov_b32 v111, 0
    v_mov_b32 v112, 0
    v_mov_b32 v113, 0
    v_mov_b32 v114, 0
    v_mov_b32 v115, 0
    v_mov_b32 v116, 0
    v_mov_b32 v117, 0
    v_mov_b32 v118, 0
    v_mov_b32 v119, 0
    v_mov_b32 v120, 0
    v_mov_b32 v121, 0
    v_mov_b32 v122, 0
    v_mov_b32 v123, 0
    v_mov_b32 v124, 0
    v_mov_b32 v125, 0
    v_mov_b32 v126, 0
    v_mov_b32 v127, 0
    v_mov_b32 v128, 0
    v_mov_b32 v129, 0
    v_mov_b32 v130, 0
    v_mov_b32 v131, 0
    v_mov_b32 v132, 0
    v_mov_b32 v133, 0
    v_mov_b32 v134, 0
    v_mov_b32 v135, 0
    v_mov_b32 v136, 0
    v_mov_b32 v137, 0
    v_mov_b32 v138, 0
    v_mov_b32 v139, 0
    v_mov_b32 v140, 0
    v_mov_b32 v141, 0
    v_mov_b32 v142, 0
    v_mov_b32 v143, 0
    v_mov_b32 v144, 0
    v_mov_b32 v145, 0
    v_mov_b32 v146, 0
    v_mov_b32 v147, 0
    v_mov_b32 v148, 0
    v_mov_b32 v149, 0
    v_mov_b32 v150, 0
    v_mov_b32 v151, 0
    v_mov_b32 v152, 0
    v_mov_b32 v153, 0
    v_mov_b32 v154, 0
    v_mov_b32 v155, 0
    v_mov_b32 v156, 0
    v_mov_b32 v157, 0
    v_mov_b32 v158, 0
    v_mov_b32 v159, 0
    v_mov_b32 v160, 0
    v_mov_b32 v161, 0
    v_mov_b32 v162, 0
    v_mov_b32 v163, 0
    v_mov_b32 v164, 0
    v_mov_b32 v165, 0
    v_mov_b32 v166, 0
    v_mov_b32 v167, 0
    v_mov_b32 v168, 0
    v_mov_b32 v169, 0
    v_mov_b32 v170, 0
    v_mov_b32 v171, 0
    v_mov_b32 v172, 0
    v_mov_b32 v173, 0
    v_mov_b32 v174, 0
    v_mov_b32 v175, 0
    v_mov_b32 v176, 0
    v_mov_b32 v177, 0
    v_mov_b32 v178, 0
    v_mov_b32 v179, 0
    v_mov_b32 v180, 0
    v_mov_b32 v181, 0
    v_mov_b32 v182, 0
    v_mov_b32 v183, 0
    v_mov_b32 v184, 0
    v_mov_b32 v185, 0
    v_mov_b32 v186, 0
    v_mov_b32 v187, 0
    v_mov_b32 v188, 0
    v_mov_b32 v189, 0
    v_mov_b32 v190, 0
    v_mov_b32 v191, 0
    v_mov_b32 v192, 0
    v_mov_b32 v193, 0
    v_mov_b32 v194, 0
    v_mov_b32 v195, 0
    v_mov_b32 v196, 0
    v_mov_b32 v197, 0
    v_mov_b32 v198, 0
    v_mov_b32 v199, 0
    v_mov_b32 v200, 0
    v_mov_b32 v201, 0
    v_mov_b32 v202, 0
    v_mov_b32 v203, 0
    v_mov_b32 v204, 0
    v_mov_b32 v205, 0
    v_mov_b32 v206, 0
    v_mov_b32 v207, 0
    v_mov_b32 v208, 0
    v_mov_b32 v209, 0
    v_mov_b32 v210, 0
    v_mov_b32 v211, 0
    v_mov_b32 v212, 0
    v_mov_b32 v213, 0
    v_mov_b32 v214, 0
    v_mov_b32 v215, 0
    s_waitcnt lgkmcnt(0)
    s_add_u32 s52, s70, 0
    s_addc_u32 s53, s71, 0
    s_mov_b32 s54, 8388608
    s_mov_b32 s55, 0x20000
    s_add_u32 s56, s74, 0
    s_addc_u32 s57, s75, 0
    s_mov_b32 s58, 3670016
    s_mov_b32 s59, 0x20000
    s_add_u32 s80, s38, 113246208
    s_addc_u32 s81, s39, 0
    s_mov_b32 s82, 3670016
    s_mov_b32 s83, 0x20000
    s_cmp_eq_u32 s33, 0
    s_cselect_b32 s54, s54, 0
    s_cselect_b32 s58, s58, 0
    s_cselect_b32 s82, s82, 0
    s_lshl_b32 s60, s2, 2
    s_add_u32 s60, s60, s3
    s_mul_i32 s60, s60, 8192
    s_lshl_b32 s61, s16, 2
    s_add_u32 s61, s61, s3
    s_mul_i32 s62, s61, 3584
    s_xor_b32 s64, s17, 1
    s_mul_i32 s63, s64, 229376
    s_add_u32 s62, s62, s63
    s_mul_i32 s61, s61, 57344
    s_lshl_b32 s63, s64, 7
    s_add_u32 s61, s61, s63
    v_lshlrev_b32 v240, 4, v0
    v_lshrrev_b32 v241, 3, v0
    v_lshlrev_b32 v241, 11, v241
    v_and_b32 v1, 7, v0
    v_lshl_add_u32 v241, v1, 4, v241
    v_cmp_gt_u32 vcc, 32, v0
    v_mov_b32 v1, 0x7fffff00
    v_cndmask_b32 v242, v1, v240, vcc
    v_cndmask_b32 v243, v1, v241, vcc
    v_mul_u32_u24 v248, 128, v0
    v_cmp_gt_u32 vcc, 28, v0
    v_lshlrev_b32 v249, 11, v0
    v_cndmask_b32 v249, v1, v249, vcc
    s_lshr_b32 s65, s2, 3
    s_mul_i32 s65, s65, 12
    s_lshr_b32 s65, s65, 5
    s_mov_b32 s28, 1
    v_add_u32 v4, 45056, v4
    v_add_u32 v5, 45056, v5
    v_add_u32 v11, 45056, v11
    v_add_u32 v12, 45056, v12
    v_add_u32 v13, 45056, v13
    v_mov_b32 v1, 1
    v_mov_b32 v2, s79
    s_waitcnt vmcnt(0)
    ds_add_u32 v2, v1 offset:0
    s_barrier
    ds_read_b128 v[16:19], v4 offset:0
    ds_read_b64_tr_b16 v[32:33], v11 offset:0
    ds_read_b64_tr_b16 v[34:35], v11 offset:1792
    ds_read_b128 v[20:23], v4 offset:2048
    ds_read_b128 v[24:27], v4 offset:4096
    ds_read_b128 v[28:31], v4 offset:6144
    ds_read_b64_tr_b16 v[36:37], v12 offset:32
    ds_read_b64_tr_b16 v[38:39], v12 offset:1824
    ds_read_b64_tr_b16 v[40:41], v11 offset:64
    ds_read_b64_tr_b16 v[42:43], v11 offset:1856
    ds_read_b64_tr_b16 v[44:45], v13 offset:0
    ds_read_b64_tr_b16 v[46:47], v13 offset:1792
    ds_read_b64_tr_b16 v[48:49], v12 offset:224
    ds_read_b64_tr_b16 v[50:51], v12 offset:2016
    ds_read_b64_tr_b16 v[52:53], v11 offset:256
    ds_read_b64_tr_b16 v[54:55], v11 offset:2048
    ds_read_b64_tr_b16 v[56:57], v12 offset:288
    ds_read_b64_tr_b16 v[58:59], v12 offset:2080
    s_mov_b32 s30, 15
    .p2align 6
cloop_22:
    s_waitcnt lgkmcnt(0)
    v_mfma_f32_16x16x32_bf16 v[104:107], v[16:19], v[32:35], v[104:107]
    ds_read_b128 v[60:63], v5 offset:0
    ds_read_b64_tr_b16 v[76:77], v11 offset:14336
    v_mfma_f32_16x16x32_bf16 v[108:111], v[16:19], v[36:39], v[108:111]
    ds_read_b64_tr_b16 v[78:79], v11 offset:16128
    ds_read_b128 v[64:67], v5 offset:2048
    v_mfma_f32_16x16x32_bf16 v[112:115], v[16:19], v[40:43], v[112:115]
    ds_read_b128 v[68:71], v5 offset:4096
    ds_read_b128 v[72:75], v5 offset:6144
    v_mfma_f32_16x16x32_bf16 v[116:119], v[16:19], v[44:47], v[116:119]
    ds_read_b64_tr_b16 v[80:81], v12 offset:14368
    ds_read_b64_tr_b16 v[82:83], v12 offset:16160
    v_mfma_f32_16x16x32_bf16 v[120:123], v[16:19], v[48:51], v[120:123]
    ds_read_b64_tr_b16 v[84:85], v11 offset:14400
    ds_read_b64_tr_b16 v[86:87], v11 offset:16192
    v_mfma_f32_16x16x32_bf16 v[124:127], v[16:19], v[52:55], v[124:127]
    ds_read_b64_tr_b16 v[88:89], v13 offset:14336
    ds_read_b64_tr_b16 v[90:91], v13 offset:16128
    v_mfma_f32_16x16x32_bf16 v[128:131], v[16:19], v[56:59], v[128:131]
    ds_read_b64_tr_b16 v[92:93], v12 offset:14560
    ds_read_b64_tr_b16 v[94:95], v12 offset:16352
    v_mfma_f32_16x16x32_bf16 v[132:135], v[20:23], v[32:35], v[132:135]
    ds_read_b64_tr_b16 v[96:97], v11 offset:14592
    ds_read_b64_tr_b16 v[98:99], v11 offset:16384
    v_mfma_f32_16x16x32_bf16 v[136:139], v[20:23], v[36:39], v[136:139]
    ds_read_b64_tr_b16 v[100:101], v12 offset:14624
    ds_read_b64_tr_b16 v[102:103], v12 offset:16416
    v_mfma_f32_16x16x32_bf16 v[140:143], v[20:23], v[40:43], v[140:143]
    s_add_u32 s28, s28, 1
    s_cmp_eq_u32 s28, 3
    v_mfma_f32_16x16x32_bf16 v[144:147], v[20:23], v[44:47], v[144:147]
    s_cselect_b32 s29, s31, 45056
    s_cselect_b32 s28, 0, s28
    v_mfma_f32_16x16x32_bf16 v[148:151], v[20:23], v[48:51], v[148:151]
    v_add_u32 v4, s29, v4
    v_add_u32 v5, s29, v5
    v_mfma_f32_16x16x32_bf16 v[152:155], v[20:23], v[52:55], v[152:155]
    v_add_u32 v11, s29, v11
    v_add_u32 v12, s29, v12
    v_mfma_f32_16x16x32_bf16 v[156:159], v[20:23], v[56:59], v[156:159]
    v_add_u32 v13, s29, v13
    v_mfma_f32_16x16x32_bf16 v[160:163], v[24:27], v[32:35], v[160:163]
    v_mfma_f32_16x16x32_bf16 v[164:167], v[24:27], v[36:39], v[164:167]
    v_mfma_f32_16x16x32_bf16 v[168:171], v[24:27], v[40:43], v[168:171]
    v_mfma_f32_16x16x32_bf16 v[172:175], v[24:27], v[44:47], v[172:175]
    v_mfma_f32_16x16x32_bf16 v[176:179], v[24:27], v[48:51], v[176:179]
    v_mfma_f32_16x16x32_bf16 v[180:183], v[24:27], v[52:55], v[180:183]
    v_mfma_f32_16x16x32_bf16 v[184:187], v[24:27], v[56:59], v[184:187]
    v_mfma_f32_16x16x32_bf16 v[188:191], v[28:31], v[32:35], v[188:191]
    v_mfma_f32_16x16x32_bf16 v[192:195], v[28:31], v[36:39], v[192:195]
    v_mfma_f32_16x16x32_bf16 v[196:199], v[28:31], v[40:43], v[196:199]
    v_mfma_f32_16x16x32_bf16 v[200:203], v[28:31], v[44:47], v[200:203]
    v_mfma_f32_16x16x32_bf16 v[204:207], v[28:31], v[48:51], v[204:207]
    v_mfma_f32_16x16x32_bf16 v[208:211], v[28:31], v[52:55], v[208:211]
    v_mfma_f32_16x16x32_bf16 v[212:215], v[28:31], v[56:59], v[212:215]
    s_waitcnt lgkmcnt(0)
    s_barrier
    v_mfma_f32_16x16x32_bf16 v[104:107], v[60:63], v[76:79], v[104:107]
    ds_read_b128 v[16:19], v4 offset:0
    v_mfma_f32_16x16x32_bf16 v[108:111], v[60:63], v[80:83], v[108:111]
    ds_read_b64_tr_b16 v[32:33], v11 offset:0
    v_mfma_f32_16x16x32_bf16 v[112:115], v[60:63], v[84:87], v[112:115]
    ds_read_b64_tr_b16 v[34:35], v11 offset:1792
    v_mfma_f32_16x16x32_bf16 v[116:119], v[60:63], v[88:91], v[116:119]
    ds_read_b128 v[20:23], v4 offset:2048
    v_mfma_f32_16x16x32_bf16 v[120:123], v[60:63], v[92:95], v[120:123]
    ds_read_b128 v[24:27], v4 offset:4096
    v_mfma_f32_16x16x32_bf16 v[124:127], v[60:63], v[96:99], v[124:127]
    ds_read_b128 v[28:31], v4 offset:6144
    v_mfma_f32_16x16x32_bf16 v[128:131], v[60:63], v[100:103], v[128:131]
    ds_read_b64_tr_b16 v[36:37], v12 offset:32
    v_mfma_f32_16x16x32_bf16 v[132:135], v[64:67], v[76:79], v[132:135]
    ds_read_b64_tr_b16 v[38:39], v12 offset:1824
    v_mfma_f32_16x16x32_bf16 v[136:139], v[64:67], v[80:83], v[136:139]
    ds_read_b64_tr_b16 v[40:41], v11 offset:64
    v_mfma_f32_16x16x32_bf16 v[140:143], v[64:67], v[84:87], v[140:143]
    ds_read_b64_tr_b16 v[42:43], v11 offset:1856
    v_mfma_f32_16x16x32_bf16 v[144:147], v[64:67], v[88:91], v[144:147]
    ds_read_b64_tr_b16 v[44:45], v13 offset:0
    v_mfma_f32_16x16x32_bf16 v[148:151], v[64:67], v[92:95], v[148:151]
    ds_read_b64_tr_b16 v[46:47], v13 offset:1792
    v_mfma_f32_16x16x32_bf16 v[152:155], v[64:67], v[96:99], v[152:155]
    ds_read_b64_tr_b16 v[48:49], v12 offset:224
    v_mfma_f32_16x16x32_bf16 v[156:159], v[64:67], v[100:103], v[156:159]
    ds_read_b64_tr_b16 v[50:51], v12 offset:2016
    v_mfma_f32_16x16x32_bf16 v[160:163], v[68:71], v[76:79], v[160:163]
    ds_read_b64_tr_b16 v[52:53], v11 offset:256
    v_mfma_f32_16x16x32_bf16 v[164:167], v[68:71], v[80:83], v[164:167]
    ds_read_b64_tr_b16 v[54:55], v11 offset:2048
    v_mfma_f32_16x16x32_bf16 v[168:171], v[68:71], v[84:87], v[168:171]
    ds_read_b64_tr_b16 v[56:57], v12 offset:288
    v_mfma_f32_16x16x32_bf16 v[172:175], v[68:71], v[88:91], v[172:175]
    ds_read_b64_tr_b16 v[58:59], v12 offset:2080
    v_mfma_f32_16x16x32_bf16 v[176:179], v[68:71], v[92:95], v[176:179]
    v_mfma_f32_16x16x32_bf16 v[180:183], v[68:71], v[96:99], v[180:183]
    v_mfma_f32_16x16x32_bf16 v[184:187], v[68:71], v[100:103], v[184:187]
    v_mfma_f32_16x16x32_bf16 v[188:191], v[72:75], v[76:79], v[188:191]
    v_mfma_f32_16x16x32_bf16 v[192:195], v[72:75], v[80:83], v[192:195]
    v_mfma_f32_16x16x32_bf16 v[196:199], v[72:75], v[84:87], v[196:199]
    v_mfma_f32_16x16x32_bf16 v[200:203], v[72:75], v[88:91], v[200:203]
    v_mfma_f32_16x16x32_bf16 v[204:207], v[72:75], v[92:95], v[204:207]
    v_mfma_f32_16x16x32_bf16 v[208:211], v[72:75], v[96:99], v[208:211]
    v_mfma_f32_16x16x32_bf16 v[212:215], v[72:75], v[100:103], v[212:215]
    s_add_u32 s64, s30, s65
    s_cmp_eq_u32 s64, 14
    s_cbranch_scc0 pf2_24
pf3_25:
    buffer_load_dword v244, v248, s[52:55], s60 offen
    s_add_u32 s60, s60, 8192
pf2_24:
    s_sub_u32 s30, s30, 1
    s_cmp_lg_u32 s30, 0
    s_cbranch_scc1 cloop_22
    s_cmp_lg_u32 s33, 0
    s_cbranch_scc1 nopk_26
    buffer_load_dwordx4 v[216:219], v241, s[56:59], s61 offen
    s_add_u32 s61, s61, 16384
    buffer_load_dwordx4 v[220:223], v241, s[56:59], s61 offen
    s_add_u32 s61, s61, 16384
    buffer_load_dwordx4 v[224:227], v241, s[56:59], s61 offen
    s_add_u32 s61, s61, 16384
    buffer_load_dwordx4 v[228:231], v243, s[56:59], s61 offen
nopk_26:
    s_waitcnt lgkmcnt(0)
    v_mfma_f32_16x16x32_bf16 v[104:107], v[16:19], v[32:35], v[104:107]
    ds_read_b128 v[60:63], v5 offset:0
    ds_read_b64_tr_b16 v[76:77], v11 offset:14336
    v_mfma_f32_16x16x32_bf16 v[108:111], v[16:19], v[36:39], v[108:111]
    ds_read_b64_tr_b16 v[78:79], v11 offset:16128
    ds_read_b128 v[64:67], v5 offset:2048
    v_mfma_f32_16x16x32_bf16 v[112:115], v[16:19], v[40:43], v[112:115]
    ds_read_b128 v[68:71], v5 offset:4096
    ds_read_b128 v[72:75], v5 offset:6144
    v_mfma_f32_16x16x32_bf16 v[116:119], v[16:19], v[44:47], v[116:119]
    ds_read_b64_tr_b16 v[80:81], v12 offset:14368
    ds_read_b64_tr_b16 v[82:83], v12 offset:16160
    v_mfma_f32_16x16x32_bf16 v[120:123], v[16:19], v[48:51], v[120:123]
    ds_read_b64_tr_b16 v[84:85], v11 offset:14400
    ds_read_b64_tr_b16 v[86:87], v11 offset:16192
    v_mfma_f32_16x16x32_bf16 v[124:127], v[16:19], v[52:55], v[124:127]
    ds_read_b64_tr_b16 v[88:89], v13 offset:14336
    ds_read_b64_tr_b16 v[90:91], v13 offset:16128
    v_mfma_f32_16x16x32_bf16 v[128:131], v[16:19], v[56:59], v[128:131]
    ds_read_b64_tr_b16 v[92:93], v12 offset:14560
    ds_read_b64_tr_b16 v[94:95], v12 offset:16352
    v_mfma_f32_16x16x32_bf16 v[132:135], v[20:23], v[32:35], v[132:135]
    ds_read_b64_tr_b16 v[96:97], v11 offset:14592
    ds_read_b64_tr_b16 v[98:99], v11 offset:16384
    v_mfma_f32_16x16x32_bf16 v[136:139], v[20:23], v[36:39], v[136:139]
    ds_read_b64_tr_b16 v[100:101], v12 offset:14624
    ds_read_b64_tr_b16 v[102:103], v12 offset:16416
    v_mfma_f32_16x16x32_bf16 v[140:143], v[20:23], v[40:43], v[140:143]
    s_add_u32 s28, s28, 1
    s_cmp_eq_u32 s28, 3
    v_mfma_f32_16x16x32_bf16 v[144:147], v[20:23], v[44:47], v[144:147]
    s_cselect_b32 s29, s31, 45056
    s_cselect_b32 s28, 0, s28
    v_mfma_f32_16x16x32_bf16 v[148:151], v[20:23], v[48:51], v[148:151]
    v_add_u32 v4, s29, v4
    v_add_u32 v5, s29, v5
    v_mfma_f32_16x16x32_bf16 v[152:155], v[20:23], v[52:55], v[152:155]
    v_add_u32 v11, s29, v11
    v_add_u32 v12, s29, v12
    v_mfma_f32_16x16x32_bf16 v[156:159], v[20:23], v[56:59], v[156:159]
    v_add_u32 v13, s29, v13
    v_mfma_f32_16x16x32_bf16 v[160:163], v[24:27], v[32:35], v[160:163]
    v_mfma_f32_16x16x32_bf16 v[164:167], v[24:27], v[36:39], v[164:167]
    v_mfma_f32_16x16x32_bf16 v[168:171], v[24:27], v[40:43], v[168:171]
    v_mfma_f32_16x16x32_bf16 v[172:175], v[24:27], v[44:47], v[172:175]
    v_mfma_f32_16x16x32_bf16 v[176:179], v[24:27], v[48:51], v[176:179]
    v_mfma_f32_16x16x32_bf16 v[180:183], v[24:27], v[52:55], v[180:183]
    v_mfma_f32_16x16x32_bf16 v[184:187], v[24:27], v[56:59], v[184:187]
    v_mfma_f32_16x16x32_bf16 v[188:191], v[28:31], v[32:35], v[188:191]
    v_mfma_f32_16x16x32_bf16 v[192:195], v[28:31], v[36:39], v[192:195]
    v_mfma_f32_16x16x32_bf16 v[196:199], v[28:31], v[40:43], v[196:199]
    v_mfma_f32_16x16x32_bf16 v[200:203], v[28:31], v[44:47], v[200:203]
    v_mfma_f32_16x16x32_bf16 v[204:207], v[28:31], v[48:51], v[204:207]
    v_mfma_f32_16x16x32_bf16 v[208:211], v[28:31], v[52:55], v[208:211]
    v_mfma_f32_16x16x32_bf16 v[212:215], v[28:31], v[56:59], v[212:215]
    s_waitcnt lgkmcnt(0)
    s_barrier
    v_mfma_f32_16x16x32_bf16 v[104:107], v[60:63], v[76:79], v[104:107]
    v_mfma_f32_16x16x32_bf16 v[108:111], v[60:63], v[80:83], v[108:111]
    v_mfma_f32_16x16x32_bf16 v[112:115], v[60:63], v[84:87], v[112:115]
    v_mfma_f32_16x16x32_bf16 v[116:119], v[60:63], v[88:91], v[116:119]
    v_mfma_f32_16x16x32_bf16 v[120:123], v[60:63], v[92:95], v[120:123]
    v_mfma_f32_16x16x32_bf16 v[124:127], v[60:63], v[96:99], v[124:127]
    v_mfma_f32_16x16x32_bf16 v[128:131], v[60:63], v[100:103], v[128:131]
    v_mfma_f32_16x16x32_bf16 v[132:135], v[64:67], v[76:79], v[132:135]
    v_mfma_f32_16x16x32_bf16 v[136:139], v[64:67], v[80:83], v[136:139]
    v_mfma_f32_16x16x32_bf16 v[140:143], v[64:67], v[84:87], v[140:143]
    v_mfma_f32_16x16x32_bf16 v[144:147], v[64:67], v[88:91], v[144:147]
    v_mfma_f32_16x16x32_bf16 v[148:151], v[64:67], v[92:95], v[148:151]
    v_mfma_f32_16x16x32_bf16 v[152:155], v[64:67], v[96:99], v[152:155]
    v_mfma_f32_16x16x32_bf16 v[156:159], v[64:67], v[100:103], v[156:159]
    v_mfma_f32_16x16x32_bf16 v[160:163], v[68:71], v[76:79], v[160:163]
    v_mfma_f32_16x16x32_bf16 v[164:167], v[68:71], v[80:83], v[164:167]
    v_mfma_f32_16x16x32_bf16 v[168:171], v[68:71], v[84:87], v[168:171]
    v_mfma_f32_16x16x32_bf16 v[172:175], v[68:71], v[88:91], v[172:175]
    v_mfma_f32_16x16x32_bf16 v[176:179], v[68:71], v[92:95], v[176:179]
    v_mfma_f32_16x16x32_bf16 v[180:183], v[68:71], v[96:99], v[180:183]
    v_mfma_f32_16x16x32_bf16 v[184:187], v[68:71], v[100:103], v[184:187]
    v_mfma_f32_16x16x32_bf16 v[188:191], v[72:75], v[76:79], v[188:191]
    v_mfma_f32_16x16x32_bf16 v[192:195], v[72:75], v[80:83], v[192:195]
    v_mfma_f32_16x16x32_bf16 v[196:199], v[72:75], v[84:87], v[196:199]
    v_mfma_f32_16x16x32_bf16 v[200:203], v[72:75], v[88:91], v[200:203]
    v_mfma_f32_16x16x32_bf16 v[204:207], v[72:75], v[92:95], v[204:207]
    v_mfma_f32_16x16x32_bf16 v[208:211], v[72:75], v[96:99], v[208:211]
    v_mfma_f32_16x16x32_bf16 v[212:215], v[72:75], v[100:103], v[212:215]
    v_mov_b32 v2, 3222493025
    v_mov_b32 v3, 3222493025
    v_mov_b32 v4, 3184710632
    v_mov_b32 v5, 3184710632
    s_add_u32 s14, s32, 16777216
    s_add_u32 s12, s38, s14
    s_addc_u32 s13, s39, 0
    s_mov_b32 s14, 7340032
    s_mov_b32 s15, 0x20000
    s_add_u32 s50, s32, 47185920
    s_add_u32 s48, s38, s50
    s_addc_u32 s49, s39, 0
    s_mov_b32 s50, 524288
    s_mov_b32 s51, 0x20000
    v_and_b32 v1, 15, v0
    v_lshlrev_b32 v1, 7, v1
    v_bfe_u32 v6, v0, 4, 1
    v_lshl_add_u32 v1, v6, 5, v1
    v_bfe_u32 v6, v0, 5, 1
    v_lshl_add_u32 v1, v6, 4, v1
    s_xor_b32 s24, s17, 1
    s_mul_i32 s24, s24, 458752
    s_lshl_b32 s46, s16, 1
    s_add_u32 s46, s46, s21
    s_mul_i32 s46, s46, 14336
    s_add_u32 s24, s24, s46
    s_lshl_b32 s47, s22, 13
    s_add_u32 s24, s24, s47
    v_lshlrev_b32 v10, 4, v0
    s_mul_i32 s46, s21, 7168
    s_lshl_b32 s47, s22, 12
    s_add_u32 s46, s46, s47
    s_add_u32 s46, s46, 15360
    v_add_u32 v9, s46, v10
    s_mul_i32 s46, s21, 7168
    s_mul_i32 s47, s22, 30720
    s_add_u32 s46, s46, s47
    s_add_u32 s46, s46, 16384
    v_add_u32 v10, s46, v10
    v_pk_mul_f32 v[16:17], v[104:105], v[104:105]
    v_pk_mul_f32 v[18:19], v[106:107], v[106:107]
    v_pk_mul_f32 v[20:21], v[132:133], v[132:133]
    v_pk_mul_f32 v[22:23], v[134:135], v[134:135]
    v_pk_fma_f32 v[16:17], v[16:17], v[4:5], v[2:3]
    v_pk_fma_f32 v[18:19], v[18:19], v[4:5], v[2:3]
    v_pk_fma_f32 v[20:21], v[20:21], v[4:5], v[2:3]
    v_pk_fma_f32 v[22:23], v[22:23], v[4:5], v[2:3]
    v_pk_mul_f32 v[16:17], v[16:17], v[104:105]
    v_pk_mul_f32 v[18:19], v[18:19], v[106:107]
    v_pk_mul_f32 v[20:21], v[20:21], v[132:133]
    v_pk_mul_f32 v[22:23], v[22:23], v[134:135]
    v_exp_f32 v16, v16
    v_exp_f32 v17, v17
    v_exp_f32 v18, v18
    v_exp_f32 v19, v19
    v_exp_f32 v20, v20
    v_exp_f32 v21, v21
    v_exp_f32 v22, v22
    v_exp_f32 v23, v23
    v_pk_add_f32 v[16:17], v[16:17], 1.0 op_sel_hi:[1,0]
    v_pk_add_f32 v[18:19], v[18:19], 1.0 op_sel_hi:[1,0]
    v_pk_add_f32 v[20:21], v[20:21], 1.0 op_sel_hi:[1,0]
    v_pk_add_f32 v[22:23], v[22:23], 1.0 op_sel_hi:[1,0]
    v_rcp_f32 v16, v16
    v_rcp_f32 v17, v17
    v_rcp_f32 v18, v18
    v_rcp_f32 v19, v19
    v_rcp_f32 v20, v20
    v_rcp_f32 v21, v21
    v_rcp_f32 v22, v22
    v_rcp_f32 v23, v23
    v_pk_mul_f32 v[104:105], v[16:17], v[104:105]
    v_pk_mul_f32 v[106:107], v[18:19], v[106:107]
    v_pk_mul_f32 v[132:133], v[20:21], v[132:133]
    v_pk_mul_f32 v[134:135], v[22:23], v[134:135]
    v_pk_mul_f32 v[16:17], v[160:161], v[160:161]
    v_pk_mul_f32 v[18:19], v[162:163], v[162:163]
    v_pk_mul_f32 v[20:21], v[188:189], v[188:189]
    v_pk_mul_f32 v[22:23], v[190:191], v[190:191]
    v_pk_fma_f32 v[16:17], v[16:17], v[4:5], v[2:3]
    v_pk_fma_f32 v[18:19], v[18:19], v[4:5], v[2:3]
    v_pk_fma_f32 v[20:21], v[20:21], v[4:5], v[2:3]
    v_pk_fma_f32 v[22:23], v[22:23], v[4:5], v[2:3]
    v_pk_mul_f32 v[16:17], v[16:17], v[160:161]
    v_pk_mul_f32 v[18:19], v[18:19], v[162:163]
    v_pk_mul_f32 v[20:21], v[20:21], v[188:189]
    v_pk_mul_f32 v[22:23], v[22:23], v[190:191]
    v_exp_f32 v16, v16
    v_exp_f32 v17, v17
    v_exp_f32 v18, v18
    v_exp_f32 v19, v19
    v_exp_f32 v20, v20
    v_exp_f32 v21, v21
    v_exp_f32 v22, v22
    v_exp_f32 v23, v23
    v_pk_add_f32 v[16:17], v[16:17], 1.0 op_sel_hi:[1,0]
    v_pk_add_f32 v[18:19], v[18:19], 1.0 op_sel_hi:[1,0]
    v_pk_add_f32 v[20:21], v[20:21], 1.0 op_sel_hi:[1,0]
    v_pk_add_f32 v[22:23], v[22:23], 1.0 op_sel_hi:[1,0]
    v_rcp_f32 v16, v16
    v_rcp_f32 v17, v17
    v_rcp_f32 v18, v18
    v_rcp_f32 v19, v19
    v_rcp_f32 v20, v20
    v_rcp_f32 v21, v21
    v_rcp_f32 v22, v22
    v_rcp_f32 v23, v23
    v_pk_mul_f32 v[160:161], v[16:17], v[160:161]
    v_pk_mul_f32 v[162:163], v[18:19], v[162:163]
    v_pk_mul_f32 v[188:189], v[20:21], v[188:189]
    v_pk_mul_f32 v[190:191], v[22:23], v[190:191]
    v_pk_mul_f32 v[72:73], v[104:105], v[104:105]
    v_pk_mul_f32 v[74:75], v[106:107], v[106:107]
    v_pk_mul_f32 v[76:77], v[132:133], v[132:133]
    v_pk_mul_f32 v[78:79], v[134:135], v[134:135]
    v_pk_mul_f32 v[80:81], v[160:161], v[160:161]
    v_pk_mul_f32 v[82:83], v[162:163], v[162:163]
    v_pk_mul_f32 v[84:85], v[188:189], v[188:189]
    v_pk_mul_f32 v[86:87], v[190:191], v[190:191]
    v_pk_mul_f32 v[16:17], v[108:109], v[108:109]
    v_pk_mul_f32 v[18:19], v[110:111], v[110:111]
    v_pk_mul_f32 v[20:21], v[136:137], v[136:137]
    v_pk_mul_f32 v[22:23], v[138:139], v[138:139]
    v_pk_fma_f32 v[16:17], v[16:17], v[4:5], v[2:3]
    v_pk_fma_f32 v[18:19], v[18:19], v[4:5], v[2:3]
    v_pk_fma_f32 v[20:21], v[20:21], v[4:5], v[2:3]
    v_pk_fma_f32 v[22:23], v[22:23], v[4:5], v[2:3]
    v_pk_mul_f32 v[16:17], v[16:17], v[108:109]
    v_pk_mul_f32 v[18:19], v[18:19], v[110:111]
    v_pk_mul_f32 v[20:21], v[20:21], v[136:137]
    v_pk_mul_f32 v[22:23], v[22:23], v[138:139]
    v_exp_f32 v16, v16
    v_exp_f32 v17, v17
    v_exp_f32 v18, v18
    v_exp_f32 v19, v19
    v_exp_f32 v20, v20
    v_exp_f32 v21, v21
    v_exp_f32 v22, v22
    v_exp_f32 v23, v23
    v_pk_add_f32 v[16:17], v[16:17], 1.0 op_sel_hi:[1,0]
    v_pk_add_f32 v[18:19], v[18:19], 1.0 op_sel_hi:[1,0]
    v_pk_add_f32 v[20:21], v[20:21], 1.0 op_sel_hi:[1,0]
    v_pk_add_f32 v[22:23], v[22:23], 1.0 op_sel_hi:[1,0]
    v_rcp_f32 v16, v16
    v_rcp_f32 v17, v17
    v_rcp_f32 v18, v18
    v_rcp_f32 v19, v19
    v_rcp_f32 v20, v20
    v_rcp_f32 v21, v21
    v_rcp_f32 v22, v22
    v_rcp_f32 v23, v23
    v_pk_mul_f32 v[108:109], v[16:17], v[108:109]
    v_pk_mul_f32 v[110:111], v[18:19], v[110:111]
    v_pk_mul_f32 v[136:137], v[20:21], v[136:137]
    v_pk_mul_f32 v[138:139], v[22:23], v[138:139]
    v_pk_mul_f32 v[16:17], v[164:165], v[164:165]
    v_pk_mul_f32 v[18:19], v[166:167], v[166:167]
    v_pk_mul_f32 v[20:21], v[192:193], v[192:193]
    v_pk_mul_f32 v[22:23], v[194:195], v[194:195]
    v_pk_fma_f32 v[16:17], v[16:17], v[4:5], v[2:3]
    v_pk_fma_f32 v[18:19], v[18:19], v[4:5], v[2:3]
    v_pk_fma_f32 v[20:21], v[20:21], v[4:5], v[2:3]
    v_pk_fma_f32 v[22:23], v[22:23], v[4:5], v[2:3]
    v_pk_mul_f32 v[16:17], v[16:17], v[164:165]
    v_pk_mul_f32 v[18:19], v[18:19], v[166:167]
    v_pk_mul_f32 v[20:21], v[20:21], v[192:193]
    v_pk_mul_f32 v[22:23], v[22:23], v[194:195]
    v_exp_f32 v16, v16
    v_exp_f32 v17, v17
    v_exp_f32 v18, v18
    v_exp_f32 v19, v19
    v_exp_f32 v20, v20
    v_exp_f32 v21, v21
    v_exp_f32 v22, v22
    v_exp_f32 v23, v23
    v_pk_add_f32 v[16:17], v[16:17], 1.0 op_sel_hi:[1,0]
    v_pk_add_f32 v[18:19], v[18:19], 1.0 op_sel_hi:[1,0]
    v_pk_add_f32 v[20:21], v[20:21], 1.0 op_sel_hi:[1,0]
    v_pk_add_f32 v[22:23], v[22:23], 1.0 op_sel_hi:[1,0]
    v_rcp_f32 v16, v16
    v_rcp_f32 v17, v17
    v_rcp_f32 v18, v18
    v_rcp_f32 v19, v19
    v_rcp_f32 v20, v20
    v_rcp_f32 v21, v21
    v_rcp_f32 v22, v22
    v_rcp_f32 v23, v23
    v_pk_mul_f32 v[164:165], v[16:17], v[164:165]
    v_pk_mul_f32 v[166:167], v[18:19], v[166:167]
    v_pk_mul_f32 v[192:193], v[20:21], v[192:193]
    v_pk_mul_f32 v[194:195], v[22:23], v[194:195]
    v_pk_add_f32 v[56:57], v[104:105], v[108:109]
    v_pk_fma_f32 v[72:73], v[108:109], v[108:109], v[72:73]
    v_pk_add_f32 v[58:59], v[106:107], v[110:111]
    v_pk_fma_f32 v[74:75], v[110:111], v[110:111], v[74:75]
    v_pk_add_f32 v[60:61], v[132:133], v[136:137]
    v_pk_fma_f32 v[76:77], v[136:137], v[136:137], v[76:77]
    v_pk_add_f32 v[62:63], v[134:135], v[138:139]
    v_pk_fma_f32 v[78:79], v[138:139], v[138:139], v[78:79]
    v_pk_add_f32 v[64:65], v[160:161], v[164:165]
    v_pk_fma_f32 v[80:81], v[164:165], v[164:165], v[80:81]
    v_pk_add_f32 v[66:67], v[162:163], v[166:167]
    v_pk_fma_f32 v[82:83], v[166:167], v[166:167], v[82:83]
    v_pk_add_f32 v[68:69], v[188:189], v[192:193]
    v_pk_fma_f32 v[84:85], v[192:193], v[192:193], v[84:85]
    v_pk_add_f32 v[70:71], v[190:191], v[194:195]
    v_pk_fma_f32 v[86:87], v[194:195], v[194:195], v[86:87]
    v_pk_mul_f32 v[16:17], v[112:113], v[112:113]
    v_pk_mul_f32 v[18:19], v[114:115], v[114:115]
    v_pk_mul_f32 v[20:21], v[140:141], v[140:141]
    v_pk_mul_f32 v[22:23], v[142:143], v[142:143]
    v_pk_fma_f32 v[16:17], v[16:17], v[4:5], v[2:3]
    v_pk_fma_f32 v[18:19], v[18:19], v[4:5], v[2:3]
    v_pk_fma_f32 v[20:21], v[20:21], v[4:5], v[2:3]
    v_pk_fma_f32 v[22:23], v[22:23], v[4:5], v[2:3]
    v_pk_mul_f32 v[16:17], v[16:17], v[112:113]
    v_pk_mul_f32 v[18:19], v[18:19], v[114:115]
    v_pk_mul_f32 v[20:21], v[20:21], v[140:141]
    v_pk_mul_f32 v[22:23], v[22:23], v[142:143]
    v_exp_f32 v16, v16
    v_exp_f32 v17, v17
    v_exp_f32 v18, v18
    v_exp_f32 v19, v19
    v_exp_f32 v20, v20
    v_exp_f32 v21, v21
    v_exp_f32 v22, v22
    v_exp_f32 v23, v23
    v_pk_add_f32 v[16:17], v[16:17], 1.0 op_sel_hi:[1,0]
    v_pk_add_f32 v[18:19], v[18:19], 1.0 op_sel_hi:[1,0]
    v_pk_add_f32 v[20:21], v[20:21], 1.0 op_sel_hi:[1,0]
    v_pk_add_f32 v[22:23], v[22:23], 1.0 op_sel_hi:[1,0]
    v_rcp_f32 v16, v16
    v_rcp_f32 v17, v17
    v_rcp_f32 v18, v18
    v_rcp_f32 v19, v19
    v_rcp_f32 v20, v20
    v_rcp_f32 v21, v21
    v_rcp_f32 v22, v22
    v_rcp_f32 v23, v23
    v_pk_mul_f32 v[112:113], v[16:17], v[112:113]
    v_pk_mul_f32 v[114:115], v[18:19], v[114:115]
    v_pk_mul_f32 v[140:141], v[20:21], v[140:141]
    v_pk_mul_f32 v[142:143], v[22:23], v[142:143]
    v_pk_mul_f32 v[16:17], v[168:169], v[168:169]
    v_pk_mul_f32 v[18:19], v[170:171], v[170:171]
    v_pk_mul_f32 v[20:21], v[196:197], v[196:197]
    v_pk_mul_f32 v[22:23], v[198:199], v[198:199]
    v_pk_fma_f32 v[16:17], v[16:17], v[4:5], v[2:3]
    v_pk_fma_f32 v[18:19], v[18:19], v[4:5], v[2:3]
    v_pk_fma_f32 v[20:21], v[20:21], v[4:5], v[2:3]
    v_pk_fma_f32 v[22:23], v[22:23], v[4:5], v[2:3]
    v_pk_mul_f32 v[16:17], v[16:17], v[168:169]
    v_pk_mul_f32 v[18:19], v[18:19], v[170:171]
    v_pk_mul_f32 v[20:21], v[20:21], v[196:197]
    v_pk_mul_f32 v[22:23], v[22:23], v[198:199]
    v_exp_f32 v16, v16
    v_exp_f32 v17, v17
    v_exp_f32 v18, v18
    v_exp_f32 v19, v19
    v_exp_f32 v20, v20
    v_exp_f32 v21, v21
    v_exp_f32 v22, v22
    v_exp_f32 v23, v23
    v_pk_add_f32 v[16:17], v[16:17], 1.0 op_sel_hi:[1,0]
    v_pk_add_f32 v[18:19], v[18:19], 1.0 op_sel_hi:[1,0]
    v_pk_add_f32 v[20:21], v[20:21], 1.0 op_sel_hi:[1,0]
    v_pk_add_f32 v[22:23], v[22:23], 1.0 op_sel_hi:[1,0]
    v_rcp_f32 v16, v16
    v_rcp_f32 v17, v17
    v_rcp_f32 v18, v18
    v_rcp_f32 v19, v19
    v_rcp_f32 v20, v20
    v_rcp_f32 v21, v21
    v_rcp_f32 v22, v22
    v_rcp_f32 v23, v23
    v_pk_mul_f32 v[168:169], v[16:17], v[168:169]
    v_pk_mul_f32 v[170:171], v[18:19], v[170:171]
    v_pk_mul_f32 v[196:197], v[20:21], v[196:197]
    v_pk_mul_f32 v[198:199], v[22:23], v[198:199]
    v_pk_add_f32 v[56:57], v[56:57], v[112:113]
    v_pk_fma_f32 v[72:73], v[112:113], v[112:113], v[72:73]
    v_pk_add_f32 v[58:59], v[58:59], v[114:115]
    v_pk_fma_f32 v[74:75], v[114:115], v[114:115], v[74:75]
    v_pk_add_f32 v[60:61], v[60:61], v[140:141]
    v_pk_fma_f32 v[76:77], v[140:141], v[140:141], v[76:77]
    v_pk_add_f32 v[62:63], v[62:63], v[142:143]
    v_pk_fma_f32 v[78:79], v[142:143], v[142:143], v[78:79]
    v_pk_add_f32 v[64:65], v[64:65], v[168:169]
    v_pk_fma_f32 v[80:81], v[168:169], v[168:169], v[80:81]
    v_pk_add_f32 v[66:67], v[66:67], v[170:171]
    v_pk_fma_f32 v[82:83], v[170:171], v[170:171], v[82:83]
    v_pk_add_f32 v[68:69], v[68:69], v[196:197]
    v_pk_fma_f32 v[84:85], v[196:197], v[196:197], v[84:85]
    v_pk_add_f32 v[70:71], v[70:71], v[198:199]
    v_pk_fma_f32 v[86:87], v[198:199], v[198:199], v[86:87]
    s_cmp_lg_u32 s22, 0
    s_cbranch_scc1 not3_27
    v_pk_mul_f32 v[16:17], v[116:117], v[116:117]
    v_pk_mul_f32 v[18:19], v[118:119], v[118:119]
    v_pk_mul_f32 v[20:21], v[144:145], v[144:145]
    v_pk_mul_f32 v[22:23], v[146:147], v[146:147]
    v_pk_fma_f32 v[16:17], v[16:17], v[4:5], v[2:3]
    v_pk_fma_f32 v[18:19], v[18:19], v[4:5], v[2:3]
    v_pk_fma_f32 v[20:21], v[20:21], v[4:5], v[2:3]
    v_pk_fma_f32 v[22:23], v[22:23], v[4:5], v[2:3]
    v_pk_mul_f32 v[16:17], v[16:17], v[116:117]
    v_pk_mul_f32 v[18:19], v[18:19], v[118:119]
    v_pk_mul_f32 v[20:21], v[20:21], v[144:145]
    v_pk_mul_f32 v[22:23], v[22:23], v[146:147]
    v_exp_f32 v16, v16
    v_exp_f32 v17, v17
    v_exp_f32 v18, v18
    v_exp_f32 v19, v19
    v_exp_f32 v20, v20
    v_exp_f32 v21, v21
    v_exp_f32 v22, v22
    v_exp_f32 v23, v23
    v_pk_add_f32 v[16:17], v[16:17], 1.0 op_sel_hi:[1,0]
    v_pk_add_f32 v[18:19], v[18:19], 1.0 op_sel_hi:[1,0]
    v_pk_add_f32 v[20:21], v[20:21], 1.0 op_sel_hi:[1,0]
    v_pk_add_f32 v[22:23], v[22:23], 1.0 op_sel_hi:[1,0]
    v_rcp_f32 v16, v16
    v_rcp_f32 v17, v17
    v_rcp_f32 v18, v18
    v_rcp_f32 v19, v19
    v_rcp_f32 v20, v20
    v_rcp_f32 v21, v21
    v_rcp_f32 v22, v22
    v_rcp_f32 v23, v23
    v_pk_mul_f32 v[116:117], v[16:17], v[116:117]
    v_pk_mul_f32 v[118:119], v[18:19], v[118:119]
    v_pk_mul_f32 v[144:145], v[20:21], v[144:145]
    v_pk_mul_f32 v[146:147], v[22:23], v[146:147]
    v_pk_mul_f32 v[16:17], v[172:173], v[172:173]
    v_pk_mul_f32 v[18:19], v[174:175], v[174:175]
    v_pk_mul_f32 v[20:21], v[200:201], v[200:201]
    v_pk_mul_f32 v[22:23], v[202:203], v[202:203]
    v_pk_fma_f32 v[16:17], v[16:17], v[4:5], v[2:3]
    v_pk_fma_f32 v[18:19], v[18:19], v[4:5], v[2:3]
    v_pk_fma_f32 v[20:21], v[20:21], v[4:5], v[2:3]
    v_pk_fma_f32 v[22:23], v[22:23], v[4:5], v[2:3]
    v_pk_mul_f32 v[16:17], v[16:17], v[172:173]
    v_pk_mul_f32 v[18:19], v[18:19], v[174:175]
    v_pk_mul_f32 v[20:21], v[20:21], v[200:201]
    v_pk_mul_f32 v[22:23], v[22:23], v[202:203]
    v_exp_f32 v16, v16
    v_exp_f32 v17, v17
    v_exp_f32 v18, v18
    v_exp_f32 v19, v19
    v_exp_f32 v20, v20
    v_exp_f32 v21, v21
    v_exp_f32 v22, v22
    v_exp_f32 v23, v23
    v_pk_add_f32 v[16:17], v[16:17], 1.0 op_sel_hi:[1,0]
    v_pk_add_f32 v[18:19], v[18:19], 1.0 op_sel_hi:[1,0]
    v_pk_add_f32 v[20:21], v[20:21], 1.0 op_sel_hi:[1,0]
    v_pk_add_f32 v[22:23], v[22:23], 1.0 op_sel_hi:[1,0]
    v_rcp_f32 v16, v16
    v_rcp_f32 v17, v17
    v_rcp_f32 v18, v18
    v_rcp_f32 v19, v19
    v_rcp_f32 v20, v20
    v_rcp_f32 v21, v21
    v_rcp_f32 v22, v22
    v_rcp_f32 v23, v23
    v_pk_mul_f32 v[172:173], v[16:17], v[172:173]
    v_pk_mul_f32 v[174:175], v[18:19], v[174:175]
    v_pk_mul_f32 v[200:201], v[20:21], v[200:201]
    v_pk_mul_f32 v[202:203], v[22:23], v[202:203]
    v_pk_add_f32 v[56:57], v[56:57], v[116:117]
    v_pk_fma_f32 v[72:73], v[116:117], v[116:117], v[72:73]
    v_pk_add_f32 v[58:59], v[58:59], v[118:119]
    v_pk_fma_f32 v[74:75], v[118:119], v[118:119], v[74:75]
    v_pk_add_f32 v[60:61], v[60:61], v[144:145]
    v_pk_fma_f32 v[76:77], v[144:145], v[144:145], v[76:77]
    v_pk_add_f32 v[62:63], v[62:63], v[146:147]
    v_pk_fma_f32 v[78:79], v[146:147], v[146:147], v[78:79]
    v_pk_add_f32 v[64:65], v[64:65], v[172:173]
    v_pk_fma_f32 v[80:81], v[172:173], v[172:173], v[80:81]
    v_pk_add_f32 v[66:67], v[66:67], v[174:175]
    v_pk_fma_f32 v[82:83], v[174:175], v[174:175], v[82:83]
    v_pk_add_f32 v[68:69], v[68:69], v[200:201]
    v_pk_fma_f32 v[84:85], v[200:201], v[200:201], v[84:85]
    v_pk_add_f32 v[70:71], v[70:71], v[202:203]
    v_pk_fma_f32 v[86:87], v[202:203], v[202:203], v[86:87]
not3_27:
    v_bfe_u32 v6, v0, 2, 1
    v_lshlrev_b32 v6, 4, v6
    v_lshrrev_b32 v7, 4, v0
    v_lshl_add_u32 v6, v7, 2, v6
    v_and_b32 v8, 3, v0
    v_add_u32 v6, v6, v8
    v_lshlrev_b32 v6, 3, v6
    v_bfe_u32 v8, v0, 3, 1
    v_lshl_add_u32 v6, v8, 13, v6
    v_add_f32_dpp v56, v56, v56 row_ror:8 row_mask:0xf bank_mask:0x3
    v_add_f32_dpp v57, v57, v57 row_ror:8 row_mask:0xf bank_mask:0x3
    v_add_f32_dpp v58, v58, v58 row_ror:8 row_mask:0xf bank_mask:0x3
    v_add_f32_dpp v59, v59, v59 row_ror:8 row_mask:0xf bank_mask:0x3
    v_add_f32_dpp v60, v60, v60 row_ror:8 row_mask:0xf bank_mask:0x3
    v_add_f32_dpp v61, v61, v61 row_ror:8 row_mask:0xf bank_mask:0x3
    v_add_f32_dpp v62, v62, v62 row_ror:8 row_mask:0xf bank_mask:0x3
    v_add_f32_dpp v63, v63, v63 row_ror:8 row_mask:0xf bank_mask:0x3
    v_add_f32_dpp v72, v72, v72 row_ror:8 row_mask:0xf bank_mask:0x3
    v_add_f32_dpp v73, v73, v73 row_ror:8 row_mask:0xf bank_mask:0x3
    v_add_f32_dpp v74, v74, v74 row_ror:8 row_mask:0xf bank_mask:0x3
    v_add_f32_dpp v75, v75, v75 row_ror:8 row_mask:0xf bank_mask:0x3
    v_add_f32_dpp v76, v76, v76 row_ror:8 row_mask:0xf bank_mask:0x3
    v_add_f32_dpp v77, v77, v77 row_ror:8 row_mask:0xf bank_mask:0x3
    v_add_f32_dpp v78, v78, v78 row_ror:8 row_mask:0xf bank_mask:0x3
    v_add_f32_dpp v79, v79, v79 row_ror:8 row_mask:0xf bank_mask:0x3
    v_add_f32_dpp v56, v64, v64 row_ror:8 row_mask:0xf bank_mask:0xc
    v_add_f32_dpp v57, v65, v65 row_ror:8 row_mask:0xf bank_mask:0xc
    v_add_f32_dpp v58, v66, v66 row_ror:8 row_mask:0xf bank_mask:0xc
    v_add_f32_dpp v59, v67, v67 row_ror:8 row_mask:0xf bank_mask:0xc
    v_add_f32_dpp v60, v68, v68 row_ror:8 row_mask:0xf bank_mask:0xc
    v_add_f32_dpp v61, v69, v69 row_ror:8 row_mask:0xf bank_mask:0xc
    v_add_f32_dpp v62, v70, v70 row_ror:8 row_mask:0xf bank_mask:0xc
    v_add_f32_dpp v63, v71, v71 row_ror:8 row_mask:0xf bank_mask:0xc
    v_add_f32_dpp v72, v80, v80 row_ror:8 row_mask:0xf bank_mask:0xc
    v_add_f32_dpp v73, v81, v81 row_ror:8 row_mask:0xf bank_mask:0xc
    v_add_f32_dpp v74, v82, v82 row_ror:8 row_mask:0xf bank_mask:0xc
    v_add_f32_dpp v75, v83, v83 row_ror:8 row_mask:0xf bank_mask:0xc
    v_add_f32_dpp v76, v84, v84 row_ror:8 row_mask:0xf bank_mask:0xc
    v_add_f32_dpp v77, v85, v85 row_ror:8 row_mask:0xf bank_mask:0xc
    v_add_f32_dpp v78, v86, v86 row_ror:8 row_mask:0xf bank_mask:0xc
    v_add_f32_dpp v79, v87, v87 row_ror:8 row_mask:0xf bank_mask:0xc
    v_add_f32_dpp v56, v56, v56 row_half_mirror row_mask:0xf bank_mask:0x5
    v_add_f32_dpp v57, v57, v57 row_half_mirror row_mask:0xf bank_mask:0x5
    v_add_f32_dpp v58, v58, v58 row_half_mirror row_mask:0xf bank_mask:0x5
    v_add_f32_dpp v59, v59, v59 row_half_mirror row_mask:0xf bank_mask:0x5
    v_add_f32_dpp v72, v72, v72 row_half_mirror row_mask:0xf bank_mask:0x5
    v_add_f32_dpp v73, v73, v73 row_half_mirror row_mask:0xf bank_mask:0x5
    v_add_f32_dpp v74, v74, v74 row_half_mirror row_mask:0xf bank_mask:0x5
    v_add_f32_dpp v75, v75, v75 row_half_mirror row_mask:0xf bank_mask:0x5
    v_add_f32_dpp v56, v60, v60 row_half_mirror row_mask:0xf bank_mask:0xa
    v_add_f32_dpp v57, v61, v61 row_half_mirror row_mask:0xf bank_mask:0xa
    v_add_f32_dpp v58, v62, v62 row_half_mirror row_mask:0xf bank_mask:0xa
    v_add_f32_dpp v59, v63, v63 row_half_mirror row_mask:0xf bank_mask:0xa
    v_add_f32_dpp v72, v76, v76 row_half_mirror row_mask:0xf bank_mask:0xa
    v_add_f32_dpp v73, v77, v77 row_half_mirror row_mask:0xf bank_mask:0xa
    v_add_f32_dpp v74, v78, v78 row_half_mirror row_mask:0xf bank_mask:0xa
    v_add_f32_dpp v75, v79, v79 row_half_mirror row_mask:0xf bank_mask:0xa
    v_add_f32_dpp v56, v56, v56 quad_perm:[1,0,3,2] row_mask:0xf bank_mask:0xf
    v_add_f32_dpp v57, v57, v57 quad_perm:[1,0,3,2] row_mask:0xf bank_mask:0xf
    v_add_f32_dpp v58, v58, v58 quad_perm:[1,0,3,2] row_mask:0xf bank_mask:0xf
    v_add_f32_dpp v59, v59, v59 quad_perm:[1,0,3,2] row_mask:0xf bank_mask:0xf
    v_add_f32_dpp v72, v72, v72 quad_perm:[1,0,3,2] row_mask:0xf bank_mask:0xf
    v_add_f32_dpp v73, v73, v73 quad_perm:[1,0,3,2] row_mask:0xf bank_mask:0xf
    v_add_f32_dpp v74, v74, v74 quad_perm:[1,0,3,2] row_mask:0xf bank_mask:0xf
    v_add_f32_dpp v75, v75, v75 quad_perm:[1,0,3,2] row_mask:0xf bank_mask:0xf
    v_add_f32_dpp v56, v56, v56 quad_perm:[2,3,0,1] row_mask:0xf bank_mask:0xf
    v_add_f32_dpp v57, v57, v57 quad_perm:[2,3,0,1] row_mask:0xf bank_mask:0xf
    v_add_f32_dpp v58, v58, v58 quad_perm:[2,3,0,1] row_mask:0xf bank_mask:0xf
    v_add_f32_dpp v59, v59, v59 quad_perm:[2,3,0,1] row_mask:0xf bank_mask:0xf
    v_add_f32_dpp v72, v72, v72 quad_perm:[2,3,0,1] row_mask:0xf bank_mask:0xf
    v_add_f32_dpp v73, v73, v73 quad_perm:[2,3,0,1] row_mask:0xf bank_mask:0xf
    v_add_f32_dpp v74, v74, v74 quad_perm:[2,3,0,1] row_mask:0xf bank_mask:0xf
    v_add_f32_dpp v75, v75, v75 quad_perm:[2,3,0,1] row_mask:0xf bank_mask:0xf
    s_mov_b32 s26, 572662306
    s_mov_b32 s27, 572662306
    v_cndmask_b32 v56, v56, v57, s[26:27]
    v_cndmask_b32 v72, v72, v73, s[26:27]
    s_mov_b32 s26, 1145324612
    s_mov_b32 s27, 1145324612
    v_cndmask_b32 v56, v56, v58, s[26:27]
    v_cndmask_b32 v72, v72, v74, s[26:27]
    s_mov_b32 s26, 2290649224
    s_mov_b32 s27, 2290649224
    v_cndmask_b32 v56, v56, v59, s[26:27]
    v_cndmask_b32 v72, v72, v75, s[26:27]
    v_max_f32 v57, 0, v72
    s_lshl_b32 s46, s16, 1
    s_add_u32 s46, s46, s21
    s_lshl_b32 s46, s46, 14
    s_lshl_b32 s47, s17, 1
    s_add_u32 s47, s47, s22
    s_lshl_b32 s47, s47, 8
    s_add_u32 s46, s46, s47
    buffer_store_dwordx2 v[56:57], v6, s[48:51], s46 offen sc1
    v_pk_mul_f32 v[16:17], v[120:121], v[120:121]
    v_pk_mul_f32 v[18:19], v[122:123], v[122:123]
    v_pk_mul_f32 v[20:21], v[148:149], v[148:149]
    v_pk_mul_f32 v[22:23], v[150:151], v[150:151]
    v_pk_fma_f32 v[16:17], v[16:17], v[4:5], v[2:3]
    v_pk_fma_f32 v[18:19], v[18:19], v[4:5], v[2:3]
    v_pk_fma_f32 v[20:21], v[20:21], v[4:5], v[2:3]
    v_pk_fma_f32 v[22:23], v[22:23], v[4:5], v[2:3]
    v_pk_mul_f32 v[16:17], v[16:17], v[120:121]
    v_pk_mul_f32 v[18:19], v[18:19], v[122:123]
    v_pk_mul_f32 v[20:21], v[20:21], v[148:149]
    v_pk_mul_f32 v[22:23], v[22:23], v[150:151]
    v_exp_f32 v16, v16
    v_exp_f32 v17, v17
    v_exp_f32 v18, v18
    v_exp_f32 v19, v19
    v_exp_f32 v20, v20
    v_exp_f32 v21, v21
    v_exp_f32 v22, v22
    v_exp_f32 v23, v23
    v_pk_add_f32 v[16:17], v[16:17], 1.0 op_sel_hi:[1,0]
    v_pk_add_f32 v[18:19], v[18:19], 1.0 op_sel_hi:[1,0]
    v_pk_add_f32 v[20:21], v[20:21], 1.0 op_sel_hi:[1,0]
    v_pk_add_f32 v[22:23], v[22:23], 1.0 op_sel_hi:[1,0]
    v_rcp_f32 v16, v16
    v_rcp_f32 v17, v17
    v_rcp_f32 v18, v18
    v_rcp_f32 v19, v19
    v_rcp_f32 v20, v20
    v_rcp_f32 v21, v21
    v_rcp_f32 v22, v22
    v_rcp_f32 v23, v23
    v_pk_mul_f32 v[120:121], v[16:17], v[120:121]
    v_pk_mul_f32 v[122:123], v[18:19], v[122:123]
    v_pk_mul_f32 v[148:149], v[20:21], v[148:149]
    v_pk_mul_f32 v[150:151], v[22:23], v[150:151]
    v_cvt_pk_bf16_f32 v32, v120, v121
    v_cvt_pk_bf16_f32 v33, v122, v123
    v_cvt_pk_bf16_f32 v34, v148, v149
    v_cvt_pk_bf16_f32 v35, v150, v151
    s_nop 0
    v_permlane16_swap_b32 v32, v34
    v_permlane16_swap_b32 v33, v35
    s_nop 0
    ds_write_b128 v9, v[32:35] offset:1024
    v_pk_mul_f32 v[16:17], v[176:177], v[176:177]
    v_pk_mul_f32 v[18:19], v[178:179], v[178:179]
    v_pk_mul_f32 v[20:21], v[204:205], v[204:205]
    v_pk_mul_f32 v[22:23], v[206:207], v[206:207]
    v_pk_fma_f32 v[16:17], v[16:17], v[4:5], v[2:3]
    v_pk_fma_f32 v[18:19], v[18:19], v[4:5], v[2:3]
    v_pk_fma_f32 v[20:21], v[20:21], v[4:5], v[2:3]
    v_pk_fma_f32 v[22:23], v[22:23], v[4:5], v[2:3]
    v_pk_mul_f32 v[16:17], v[16:17], v[176:177]
    v_pk_mul_f32 v[18:19], v[18:19], v[178:179]
    v_pk_mul_f32 v[20:21], v[20:21], v[204:205]
    v_pk_mul_f32 v[22:23], v[22:23], v[206:207]
    v_exp_f32 v16, v16
    v_exp_f32 v17, v17
    v_exp_f32 v18, v18
    v_exp_f32 v19, v19
    v_exp_f32 v20, v20
    v_exp_f32 v21, v21
    v_exp_f32 v22, v22
    v_exp_f32 v23, v23
    v_pk_add_f32 v[16:17], v[16:17], 1.0 op_sel_hi:[1,0]
    v_pk_add_f32 v[18:19], v[18:19], 1.0 op_sel_hi:[1,0]
    v_pk_add_f32 v[20:21], v[20:21], 1.0 op_sel_hi:[1,0]
    v_pk_add_f32 v[22:23], v[22:23], 1.0 op_sel_hi:[1,0]
    v_rcp_f32 v16, v16
    v_rcp_f32 v17, v17
    v_rcp_f32 v18, v18
    v_rcp_f32 v19, v19
    v_rcp_f32 v20, v20
    v_rcp_f32 v21, v21
    v_rcp_f32 v22, v22
    v_rcp_f32 v23, v23
    v_pk_mul_f32 v[176:177], v[16:17], v[176:177]
    v_pk_mul_f32 v[178:179], v[18:19], v[178:179]
    v_pk_mul_f32 v[204:205], v[20:21], v[204:205]
    v_pk_mul_f32 v[206:207], v[22:23], v[206:207]
    v_cvt_pk_bf16_f32 v36, v176, v177
    v_cvt_pk_bf16_f32 v37, v178, v179
    v_cvt_pk_bf16_f32 v38, v204, v205
    v_cvt_pk_bf16_f32 v39, v206, v207
    s_nop 0
    v_permlane16_swap_b32 v36, v38
    v_permlane16_swap_b32 v37, v39
    s_nop 0
    ds_write_b128 v9, v[36:39] offset:31744
    v_pk_mul_f32 v[16:17], v[124:125], v[124:125]
    v_pk_mul_f32 v[18:19], v[126:127], v[126:127]
    v_pk_mul_f32 v[20:21], v[152:153], v[152:153]
    v_pk_mul_f32 v[22:23], v[154:155], v[154:155]
    v_pk_fma_f32 v[16:17], v[16:17], v[4:5], v[2:3]
    v_pk_fma_f32 v[18:19], v[18:19], v[4:5], v[2:3]
    v_pk_fma_f32 v[20:21], v[20:21], v[4:5], v[2:3]
    v_pk_fma_f32 v[22:23], v[22:23], v[4:5], v[2:3]
    v_pk_mul_f32 v[16:17], v[16:17], v[124:125]
    v_pk_mul_f32 v[18:19], v[18:19], v[126:127]
    v_pk_mul_f32 v[20:21], v[20:21], v[152:153]
    v_pk_mul_f32 v[22:23], v[22:23], v[154:155]
    v_exp_f32 v16, v16
    v_exp_f32 v17, v17
    v_exp_f32 v18, v18
    v_exp_f32 v19, v19
    v_exp_f32 v20, v20
    v_exp_f32 v21, v21
    v_exp_f32 v22, v22
    v_exp_f32 v23, v23
    v_pk_add_f32 v[16:17], v[16:17], 1.0 op_sel_hi:[1,0]
    v_pk_add_f32 v[18:19], v[18:19], 1.0 op_sel_hi:[1,0]
    v_pk_add_f32 v[20:21], v[20:21], 1.0 op_sel_hi:[1,0]
    v_pk_add_f32 v[22:23], v[22:23], 1.0 op_sel_hi:[1,0]
    v_rcp_f32 v16, v16
    v_rcp_f32 v17, v17
    v_rcp_f32 v18, v18
    v_rcp_f32 v19, v19
    v_rcp_f32 v20, v20
    v_rcp_f32 v21, v21
    v_rcp_f32 v22, v22
    v_rcp_f32 v23, v23
    v_pk_mul_f32 v[124:125], v[16:17], v[124:125]
    v_pk_mul_f32 v[126:127], v[18:19], v[126:127]
    v_pk_mul_f32 v[152:153], v[20:21], v[152:153]
    v_pk_mul_f32 v[154:155], v[22:23], v[154:155]
    v_cvt_pk_bf16_f32 v40, v124, v125
    v_cvt_pk_bf16_f32 v41, v126, v127
    v_cvt_pk_bf16_f32 v42, v152, v153
    v_cvt_pk_bf16_f32 v43, v154, v155
    s_nop 0
    v_permlane16_swap_b32 v40, v42
    v_permlane16_swap_b32 v41, v43
    s_nop 0
    ds_write_b128 v9, v[40:43] offset:2048
    v_pk_mul_f32 v[16:17], v[180:181], v[180:181]
    v_pk_mul_f32 v[18:19], v[182:183], v[182:183]
    v_pk_mul_f32 v[20:21], v[208:209], v[208:209]
    v_pk_mul_f32 v[22:23], v[210:211], v[210:211]
    v_pk_fma_f32 v[16:17], v[16:17], v[4:5], v[2:3]
    v_pk_fma_f32 v[18:19], v[18:19], v[4:5], v[2:3]
    v_pk_fma_f32 v[20:21], v[20:21], v[4:5], v[2:3]
    v_pk_fma_f32 v[22:23], v[22:23], v[4:5], v[2:3]
    v_pk_mul_f32 v[16:17], v[16:17], v[180:181]
    v_pk_mul_f32 v[18:19], v[18:19], v[182:183]
    v_pk_mul_f32 v[20:21], v[20:21], v[208:209]
    v_pk_mul_f32 v[22:23], v[22:23], v[210:211]
    v_exp_f32 v16, v16
    v_exp_f32 v17, v17
    v_exp_f32 v18, v18
    v_exp_f32 v19, v19
    v_exp_f32 v20, v20
    v_exp_f32 v21, v21
    v_exp_f32 v22, v22
    v_exp_f32 v23, v23
    v_pk_add_f32 v[16:17], v[16:17], 1.0 op_sel_hi:[1,0]
    v_pk_add_f32 v[18:19], v[18:19], 1.0 op_sel_hi:[1,0]
    v_pk_add_f32 v[20:21], v[20:21], 1.0 op_sel_hi:[1,0]
    v_pk_add_f32 v[22:23], v[22:23], 1.0 op_sel_hi:[1,0]
    v_rcp_f32 v16, v16
    v_rcp_f32 v17, v17
    v_rcp_f32 v18, v18
    v_rcp_f32 v19, v19
    v_rcp_f32 v20, v20
    v_rcp_f32 v21, v21
    v_rcp_f32 v22, v22
    v_rcp_f32 v23, v23
    v_pk_mul_f32 v[180:181], v[16:17], v[180:181]
    v_pk_mul_f32 v[182:183], v[18:19], v[182:183]
    v_pk_mul_f32 v[208:209], v[20:21], v[208:209]
    v_pk_mul_f32 v[210:211], v[22:23], v[210:211]
    v_cvt_pk_bf16_f32 v44, v180, v181
    v_cvt_pk_bf16_f32 v45, v182, v183
    v_cvt_pk_bf16_f32 v46, v208, v209
    v_cvt_pk_bf16_f32 v47, v210, v211
    s_nop 0
    v_permlane16_swap_b32 v44, v46
    v_permlane16_swap_b32 v45, v47
    s_nop 0
    ds_write_b128 v9, v[44:47] offset:32768
    v_pk_mul_f32 v[16:17], v[128:129], v[128:129]
    v_pk_mul_f32 v[18:19], v[130:131], v[130:131]
    v_pk_mul_f32 v[20:21], v[156:157], v[156:157]
    v_pk_mul_f32 v[22:23], v[158:159], v[158:159]
    v_pk_fma_f32 v[16:17], v[16:17], v[4:5], v[2:3]
    v_pk_fma_f32 v[18:19], v[18:19], v[4:5], v[2:3]
    v_pk_fma_f32 v[20:21], v[20:21], v[4:5], v[2:3]
    v_pk_fma_f32 v[22:23], v[22:23], v[4:5], v[2:3]
    v_pk_mul_f32 v[16:17], v[16:17], v[128:129]
    v_pk_mul_f32 v[18:19], v[18:19], v[130:131]
    v_pk_mul_f32 v[20:21], v[20:21], v[156:157]
    v_pk_mul_f32 v[22:23], v[22:23], v[158:159]
    v_exp_f32 v16, v16
    v_exp_f32 v17, v17
    v_exp_f32 v18, v18
    v_exp_f32 v19, v19
    v_exp_f32 v20, v20
    v_exp_f32 v21, v21
    v_exp_f32 v22, v22
    v_exp_f32 v23, v23
    v_pk_add_f32 v[16:17], v[16:17], 1.0 op_sel_hi:[1,0]
    v_pk_add_f32 v[18:19], v[18:19], 1.0 op_sel_hi:[1,0]
    v_pk_add_f32 v[20:21], v[20:21], 1.0 op_sel_hi:[1,0]
    v_pk_add_f32 v[22:23], v[22:23], 1.0 op_sel_hi:[1,0]
    v_rcp_f32 v16, v16
    v_rcp_f32 v17, v17
    v_rcp_f32 v18, v18
    v_rcp_f32 v19, v19
    v_rcp_f32 v20, v20
    v_rcp_f32 v21, v21
    v_rcp_f32 v22, v22
    v_rcp_f32 v23, v23
    v_pk_mul_f32 v[128:129], v[16:17], v[128:129]
    v_pk_mul_f32 v[130:131], v[18:19], v[130:131]
    v_pk_mul_f32 v[156:157], v[20:21], v[156:157]
    v_pk_mul_f32 v[158:159], v[22:23], v[158:159]
    v_cvt_pk_bf16_f32 v32, v128, v129
    v_cvt_pk_bf16_f32 v33, v130, v131
    v_cvt_pk_bf16_f32 v34, v156, v157
    v_cvt_pk_bf16_f32 v35, v158, v159
    s_nop 0
    v_permlane16_swap_b32 v32, v34
    v_permlane16_swap_b32 v33, v35
    s_nop 0
    ds_write_b128 v9, v[32:35] offset:3072
    v_pk_mul_f32 v[16:17], v[184:185], v[184:185]
    v_pk_mul_f32 v[18:19], v[186:187], v[186:187]
    v_pk_mul_f32 v[20:21], v[212:213], v[212:213]
    v_pk_mul_f32 v[22:23], v[214:215], v[214:215]
    v_pk_fma_f32 v[16:17], v[16:17], v[4:5], v[2:3]
    v_pk_fma_f32 v[18:19], v[18:19], v[4:5], v[2:3]
    v_pk_fma_f32 v[20:21], v[20:21], v[4:5], v[2:3]
    v_pk_fma_f32 v[22:23], v[22:23], v[4:5], v[2:3]
    v_pk_mul_f32 v[16:17], v[16:17], v[184:185]
    v_pk_mul_f32 v[18:19], v[18:19], v[186:187]
    v_pk_mul_f32 v[20:21], v[20:21], v[212:213]
    v_pk_mul_f32 v[22:23], v[22:23], v[214:215]
    v_exp_f32 v16, v16
    v_exp_f32 v17, v17
    v_exp_f32 v18, v18
    v_exp_f32 v19, v19
    v_exp_f32 v20, v20
    v_exp_f32 v21, v21
    v_exp_f32 v22, v22
    v_exp_f32 v23, v23
    v_pk_add_f32 v[16:17], v[16:17], 1.0 op_sel_hi:[1,0]
    v_pk_add_f32 v[18:19], v[18:19], 1.0 op_sel_hi:[1,0]
    v_pk_add_f32 v[20:21], v[20:21], 1.0 op_sel_hi:[1,0]
    v_pk_add_f32 v[22:23], v[22:23], 1.0 op_sel_hi:[1,0]
    v_rcp_f32 v16, v16
    v_rcp_f32 v17, v17
    v_rcp_f32 v18, v18
    v_rcp_f32 v19, v19
    v_rcp_f32 v20, v20
    v_rcp_f32 v21, v21
    v_rcp_f32 v22, v22
    v_rcp_f32 v23, v23
    v_pk_mul_f32 v[184:185], v[16:17], v[184:185]
    v_pk_mul_f32 v[186:187], v[18:19], v[186:187]
    v_pk_mul_f32 v[212:213], v[20:21], v[212:213]
    v_pk_mul_f32 v[214:215], v[22:23], v[214:215]
    v_cvt_pk_bf16_f32 v36, v184, v185
    v_cvt_pk_bf16_f32 v37, v186, v187
    v_cvt_pk_bf16_f32 v38, v212, v213
    v_cvt_pk_bf16_f32 v39, v214, v215
    s_nop 0
    v_permlane16_swap_b32 v36, v38
    v_permlane16_swap_b32 v37, v39
    s_nop 0
    ds_write_b128 v9, v[36:39] offset:33792
    s_cmp_eq_u32 s22, 0
    s_cbranch_scc1 not3z_28
    v_pk_mul_f32 v[16:17], v[116:117], v[116:117]
    v_pk_mul_f32 v[18:19], v[118:119], v[118:119]
    v_pk_mul_f32 v[20:21], v[144:145], v[144:145]
    v_pk_mul_f32 v[22:23], v[146:147], v[146:147]
    v_pk_fma_f32 v[16:17], v[16:17], v[4:5], v[2:3]
    v_pk_fma_f32 v[18:19], v[18:19], v[4:5], v[2:3]
    v_pk_fma_f32 v[20:21], v[20:21], v[4:5], v[2:3]
    v_pk_fma_f32 v[22:23], v[22:23], v[4:5], v[2:3]
    v_pk_mul_f32 v[16:17], v[16:17], v[116:117]
    v_pk_mul_f32 v[18:19], v[18:19], v[118:119]
    v_pk_mul_f32 v[20:21], v[20:21], v[144:145]
    v_pk_mul_f32 v[22:23], v[22:23], v[146:147]
    v_exp_f32 v16, v16
    v_exp_f32 v17, v17
    v_exp_f32 v18, v18
    v_exp_f32 v19, v19
    v_exp_f32 v20, v20
    v_exp_f32 v21, v21
    v_exp_f32 v22, v22
    v_exp_f32 v23, v23
    v_pk_add_f32 v[16:17], v[16:17], 1.0 op_sel_hi:[1,0]
    v_pk_add_f32 v[18:19], v[18:19], 1.0 op_sel_hi:[1,0]
    v_pk_add_f32 v[20:21], v[20:21], 1.0 op_sel_hi:[1,0]
    v_pk_add_f32 v[22:23], v[22:23], 1.0 op_sel_hi:[1,0]
    v_rcp_f32 v16, v16
    v_rcp_f32 v17, v17
    v_rcp_f32 v18, v18
    v_rcp_f32 v19, v19
    v_rcp_f32 v20, v20
    v_rcp_f32 v21, v21
    v_rcp_f32 v22, v22
    v_rcp_f32 v23, v23
    v_pk_mul_f32 v[116:117], v[16:17], v[116:117]
    v_pk_mul_f32 v[118:119], v[18:19], v[118:119]
    v_pk_mul_f32 v[144:145], v[20:21], v[144:145]
    v_pk_mul_f32 v[146:147], v[22:23], v[146:147]
    v_cvt_pk_bf16_f32 v40, v116, v117
    v_cvt_pk_bf16_f32 v41, v118, v119
    v_cvt_pk_bf16_f32 v42, v144, v145
    v_cvt_pk_bf16_f32 v43, v146, v147
    s_nop 0
    v_permlane16_swap_b32 v40, v42
    v_permlane16_swap_b32 v41, v43
    s_nop 0
    ds_write_b128 v9, v[40:43] offset:0
    v_pk_mul_f32 v[16:17], v[172:173], v[172:173]
    v_pk_mul_f32 v[18:19], v[174:175], v[174:175]
    v_pk_mul_f32 v[20:21], v[200:201], v[200:201]
    v_pk_mul_f32 v[22:23], v[202:203], v[202:203]
    v_pk_fma_f32 v[16:17], v[16:17], v[4:5], v[2:3]
    v_pk_fma_f32 v[18:19], v[18:19], v[4:5], v[2:3]
    v_pk_fma_f32 v[20:21], v[20:21], v[4:5], v[2:3]
    v_pk_fma_f32 v[22:23], v[22:23], v[4:5], v[2:3]
    v_pk_mul_f32 v[16:17], v[16:17], v[172:173]
    v_pk_mul_f32 v[18:19], v[18:19], v[174:175]
    v_pk_mul_f32 v[20:21], v[20:21], v[200:201]
    v_pk_mul_f32 v[22:23], v[22:23], v[202:203]
    v_exp_f32 v16, v16
    v_exp_f32 v17, v17
    v_exp_f32 v18, v18
    v_exp_f32 v19, v19
    v_exp_f32 v20, v20
    v_exp_f32 v21, v21
    v_exp_f32 v22, v22
    v_exp_f32 v23, v23
    v_pk_add_f32 v[16:17], v[16:17], 1.0 op_sel_hi:[1,0]
    v_pk_add_f32 v[18:19], v[18:19], 1.0 op_sel_hi:[1,0]
    v_pk_add_f32 v[20:21], v[20:21], 1.0 op_sel_hi:[1,0]
    v_pk_add_f32 v[22:23], v[22:23], 1.0 op_sel_hi:[1,0]
    v_rcp_f32 v16, v16
    v_rcp_f32 v17, v17
    v_rcp_f32 v18, v18
    v_rcp_f32 v19, v19
    v_rcp_f32 v20, v20
    v_rcp_f32 v21, v21
    v_rcp_f32 v22, v22
    v_rcp_f32 v23, v23
    v_pk_mul_f32 v[172:173], v[16:17], v[172:173]
    v_pk_mul_f32 v[174:175], v[18:19], v[174:175]
    v_pk_mul_f32 v[200:201], v[20:21], v[200:201]
    v_pk_mul_f32 v[202:203], v[22:23], v[202:203]
    v_cvt_pk_bf16_f32 v44, v172, v173
    v_cvt_pk_bf16_f32 v45, v174, v175
    v_cvt_pk_bf16_f32 v46, v200, v201
    v_cvt_pk_bf16_f32 v47, v202, v203
    s_nop 0
    v_permlane16_swap_b32 v44, v46
    v_permlane16_swap_b32 v45, v47
    s_nop 0
    ds_write_b128 v9, v[44:47] offset:30720
not3z_28:
    s_cmp_lg_u32 s33, 0
    s_cbranch_scc1 nopk_29
    s_waitcnt vmcnt(0)
    buffer_store_dwordx4 v[216:219], v240, s[80:83], s62 offen offset:0 sc1
    buffer_store_dwordx4 v[220:223], v240, s[80:83], s62 offen offset:1024 sc1
    buffer_store_dwordx4 v[224:227], v240, s[80:83], s62 offen offset:2048 sc1
    buffer_store_dwordx4 v[228:231], v242, s[80:83], s62 offen offset:3072 sc1
nopk_29:
    v_lshlrev_b32 v7, 4, v7
    s_lshl_b32 s46, s21, 8
    s_add_u32 s46, s46, 153600
    v_add_u32 v7, s46, v7
    s_waitcnt lgkmcnt(0)
    s_barrier
    ds_read_b128 v[56:59], v7 offset:0
    ds_read_b128 v[60:63], v7 offset:512
    ds_read_b128 v[64:67], v7 offset:64
    ds_read_b128 v[68:71], v7 offset:576
    ds_read_b128 v[72:75], v7 offset:128
    ds_read_b128 v[76:79], v7 offset:640
    ds_read_b128 v[80:83], v7 offset:192
    ds_read_b128 v[84:87], v7 offset:704
    ds_read_b128 v[216:219], v10 offset:0
    ds_read_b128 v[220:223], v10 offset:1024
    ds_read_b128 v[224:227], v10 offset:2048
    ds_read_b128 v[228:231], v10 offset:3072
    ds_read_b128 v[232:235], v10 offset:4096
    ds_read_b128 v[236:239], v10 offset:5120
    ds_read_b128 v[240:243], v10 offset:6144
    s_waitcnt lgkmcnt(7)
    v_pk_fma_f32 v[104:105], v[104:105], v[56:57], v[60:61]
    v_pk_fma_f32 v[106:107], v[106:107], v[58:59], v[62:63]
    v_pk_fma_f32 v[132:133], v[132:133], v[64:65], v[68:69]
    v_pk_fma_f32 v[134:135], v[134:135], v[66:67], v[70:71]
    v_pk_fma_f32 v[160:161], v[160:161], v[72:73], v[76:77]
    v_pk_fma_f32 v[162:163], v[162:163], v[74:75], v[78:79]
    v_pk_fma_f32 v[188:189], v[188:189], v[80:81], v[84:85]
    v_pk_fma_f32 v[190:191], v[190:191], v[82:83], v[86:87]
    v_cvt_pk_bf16_f32 v32, v104, v105
    v_cvt_pk_bf16_f32 v33, v106, v107
    v_cvt_pk_bf16_f32 v34, v132, v133
    v_cvt_pk_bf16_f32 v35, v134, v135
    s_nop 0
    v_permlane16_swap_b32 v32, v34
    v_permlane16_swap_b32 v33, v35
    buffer_store_dwordx4 v[32:35], v1, s[12:15], s24 offen offset:0 sc1
    v_cvt_pk_bf16_f32 v36, v160, v161
    v_cvt_pk_bf16_f32 v37, v162, v163
    v_cvt_pk_bf16_f32 v38, v188, v189
    v_cvt_pk_bf16_f32 v39, v190, v191
    s_nop 0
    v_permlane16_swap_b32 v36, v38
    v_permlane16_swap_b32 v37, v39
    buffer_store_dwordx4 v[36:39], v1, s[12:15], s24 offen offset:64 sc1
    s_add_u32 s24, s24, 2048
    v_pk_fma_f32 v[108:109], v[108:109], v[56:57], v[60:61]
    v_pk_fma_f32 v[110:111], v[110:111], v[58:59], v[62:63]
    v_pk_fma_f32 v[136:137], v[136:137], v[64:65], v[68:69]
    v_pk_fma_f32 v[138:139], v[138:139], v[66:67], v[70:71]
    v_pk_fma_f32 v[164:165], v[164:165], v[72:73], v[76:77]
    v_pk_fma_f32 v[166:167], v[166:167], v[74:75], v[78:79]
    v_pk_fma_f32 v[192:193], v[192:193], v[80:81], v[84:85]
    v_pk_fma_f32 v[194:195], v[194:195], v[82:83], v[86:87]
    v_cvt_pk_bf16_f32 v40, v108, v109
    v_cvt_pk_bf16_f32 v41, v110, v111
    v_cvt_pk_bf16_f32 v42, v136, v137
    v_cvt_pk_bf16_f32 v43, v138, v139
    s_nop 0
    v_permlane16_swap_b32 v40, v42
    v_permlane16_swap_b32 v41, v43
    buffer_store_dwordx4 v[40:43], v1, s[12:15], s24 offen offset:0 sc1
    v_cvt_pk_bf16_f32 v44, v164, v165
    v_cvt_pk_bf16_f32 v45, v166, v167
    v_cvt_pk_bf16_f32 v46, v192, v193
    v_cvt_pk_bf16_f32 v47, v194, v195
    s_nop 0
    v_permlane16_swap_b32 v44, v46
    v_permlane16_swap_b32 v45, v47
    buffer_store_dwordx4 v[44:47], v1, s[12:15], s24 offen offset:64 sc1
    s_add_u32 s24, s24, 2048
    v_pk_fma_f32 v[112:113], v[112:113], v[56:57], v[60:61]
    v_pk_fma_f32 v[114:115], v[114:115], v[58:59], v[62:63]
    v_pk_fma_f32 v[140:141], v[140:141], v[64:65], v[68:69]
    v_pk_fma_f32 v[142:143], v[142:143], v[66:67], v[70:71]
    v_pk_fma_f32 v[168:169], v[168:169], v[72:73], v[76:77]
    v_pk_fma_f32 v[170:171], v[170:171], v[74:75], v[78:79]
    v_pk_fma_f32 v[196:197], v[196:197], v[80:81], v[84:85]
    v_pk_fma_f32 v[198:199], v[198:199], v[82:83], v[86:87]
    v_cvt_pk_bf16_f32 v32, v112, v113
    v_cvt_pk_bf16_f32 v33, v114, v115
    v_cvt_pk_bf16_f32 v34, v140, v141
    v_cvt_pk_bf16_f32 v35, v142, v143
    s_nop 0
    v_permlane16_swap_b32 v32, v34
    v_permlane16_swap_b32 v33, v35
    buffer_store_dwordx4 v[32:35], v1, s[12:15], s24 offen offset:0 sc1
    v_cvt_pk_bf16_f32 v36, v168, v169
    v_cvt_pk_bf16_f32 v37, v170, v171
    v_cvt_pk_bf16_f32 v38, v196, v197
    v_cvt_pk_bf16_f32 v39, v198, v199
    s_nop 0
    v_permlane16_swap_b32 v36, v38
    v_permlane16_swap_b32 v37, v39
    buffer_store_dwordx4 v[36:39], v1, s[12:15], s24 offen offset:64 sc1
    s_add_u32 s24, s24, 2048
    s_cmp_lg_u32 s22, 0
    s_cbranch_scc1 not3n_30
    v_pk_fma_f32 v[116:117], v[116:117], v[56:57], v[60:61]
    v_pk_fma_f32 v[118:119], v[118:119], v[58:59], v[62:63]
    v_pk_fma_f32 v[144:145], v[144:145], v[64:65], v[68:69]
    v_pk_fma_f32 v[146:147], v[146:147], v[66:67], v[70:71]
    v_pk_fma_f32 v[172:173], v[172:173], v[72:73], v[76:77]
    v_pk_fma_f32 v[174:175], v[174:175], v[74:75], v[78:79]
    v_pk_fma_f32 v[200:201], v[200:201], v[80:81], v[84:85]
    v_pk_fma_f32 v[202:203], v[202:203], v[82:83], v[86:87]
    v_cvt_pk_bf16_f32 v40, v116, v117
    v_cvt_pk_bf16_f32 v41, v118, v119
    v_cvt_pk_bf16_f32 v42, v144, v145
    v_cvt_pk_bf16_f32 v43, v146, v147
    s_nop 0
    v_permlane16_swap_b32 v40, v42
    v_permlane16_swap_b32 v41, v43
    buffer_store_dwordx4 v[40:43], v1, s[12:15], s24 offen offset:0 sc1
    v_cvt_pk_bf16_f32 v44, v172, v173
    v_cvt_pk_bf16_f32 v45, v174, v175
    v_cvt_pk_bf16_f32 v46, v200, v201
    v_cvt_pk_bf16_f32 v47, v202, v203
    s_nop 0
    v_permlane16_swap_b32 v44, v46
    v_permlane16_swap_b32 v45, v47
    buffer_store_dwordx4 v[44:47], v1, s[12:15], s24 offen offset:64 sc1
not3n_30:
    s_waitcnt lgkmcnt(0)
    s_and_b32 s18, s2, 7
    s_lshr_b32 s19, s2, 3
    s_and_b32 s16, s18, 3
    s_lshl_b32 s16, s16, 2
    s_and_b32 s20, s19, 3
    s_add_u32 s16, s16, s20
    s_lshr_b32 s17, s18, 2
    s_lshl_b32 s17, s17, 3
    s_lshr_b32 s20, s19, 2
    s_add_u32 s17, s17, s20
    s_mov_b32 s31, 4294844416
    s_and_b32 s21, s3, 1
    s_lshr_b32 s22, s3, 1
    v_and_b32 v15, 15, v0
    v_lshlrev_b32 v15, 8, v15
    v_bfe_u32 v6, v0, 4, 1
    v_lshlrev_b32 v7, 5, v6
    v_bfe_u32 v6, v0, 5, 1
    v_lshl_add_u32 v7, v6, 4, v7
    v_add_u32 v15, v15, v7
    s_lshl_b32 s43, s21, 7
    s_lshl_b32 s24, s22, 6
    s_add_u32 s43, s43, s24
    s_mul_i32 s42, s17, 28672
    s_add_u32 s42, s42, s43
    s_mul_i32 s24, s16, 458752
    s_add_u32 s42, s42, s24
    s_lshl_b32 s24, s16, 8
    s_add_u32 s43, s43, s24
    v_mov_b32 v248, v7
    v_and_b32 v1, 15, v0
    v_lshrrev_b32 v2, 4, v0
    v_lshrrev_b32 v3, 1, v1
    v_xor_b32 v3, v2, v3
    v_lshlrev_b32 v3, 4, v3
    v_lshl_add_u32 v3, v1, 7, v3
    s_lshl_b32 s24, s22, 6
    v_xor_b32 v3, s24, v3
    s_lshl_b32 s23, s21, 13
    s_lshl_b32 s24, s22, 12
    s_add_u32 s25, s23, s24
    s_xor_b32 s26, s25, 4096
    v_add_u32 v4, s25, v3
    v_add_u32 v5, s26, v3
    v_add_u32 v11, 16384, v3
    v_mov_b32 v104, 0
    v_mov_b32 v105, 0
    v_mov_b32 v106, 0
    v_mov_b32 v107, 0
    v_mov_b32 v108, 0
    v_mov_b32 v109, 0
    v_mov_b32 v110, 0
    v_mov_b32 v111, 0
    v_mov_b32 v112, 0
    v_mov_b32 v113, 0
    v_mov_b32 v114, 0
    v_mov_b32 v115, 0
    v_mov_b32 v116, 0
    v_mov_b32 v117, 0
    v_mov_b32 v118, 0
    v_mov_b32 v119, 0
    v_mov_b32 v120, 0
    v_mov_b32 v121, 0
    v_mov_b32 v122, 0
    v_mov_b32 v123, 0
    v_mov_b32 v124, 0
    v_mov_b32 v125, 0
    v_mov_b32 v126, 0
    v_mov_b32 v127, 0
    v_mov_b32 v128, 0
    v_mov_b32 v129, 0
    v_mov_b32 v130, 0
    v_mov_b32 v131, 0
    v_mov_b32 v132, 0
    v_mov_b32 v133, 0
    v_mov_b32 v134, 0
    v_mov_b32 v135, 0
    v_mov_b32 v136, 0
    v_mov_b32 v137, 0
    v_mov_b32 v138, 0
    v_mov_b32 v139, 0
    v_mov_b32 v140, 0
    v_mov_b32 v141, 0
    v_mov_b32 v142, 0
    v_mov_b32 v143, 0
    v_mov_b32 v144, 0
    v_mov_b32 v145, 0
    v_mov_b32 v146, 0
    v_mov_b32 v147, 0
    v_mov_b32 v148, 0
    v_mov_b32 v149, 0
    v_mov_b32 v150, 0
    v_mov_b32 v151, 0
    v_mov_b32 v152, 0
    v_mov_b32 v153, 0
    v_mov_b32 v154, 0
    v_mov_b32 v155, 0
    v_mov_b32 v156, 0
    v_mov_b32 v157, 0
    v_mov_b32 v158, 0
    v_mov_b32 v159, 0
    v_mov_b32 v160, 0
    v_mov_b32 v161, 0
    v_mov_b32 v162, 0
    v_mov_b32 v163, 0
    v_mov_b32 v164, 0
    v_mov_b32 v165, 0
    v_mov_b32 v166, 0
    v_mov_b32 v167, 0
    v_mov_b32 v168, 0
    v_mov_b32 v169, 0
    v_mov_b32 v170, 0
    v_mov_b32 v171, 0
    v_mov_b32 v172, 0
    v_mov_b32 v173, 0
    v_mov_b32 v174, 0
    v_mov_b32 v175, 0
    v_mov_b32 v176, 0
    v_mov_b32 v177, 0
    v_mov_b32 v178, 0
    v_mov_b32 v179, 0
    v_mov_b32 v180, 0
    v_mov_b32 v181, 0
    v_mov_b32 v182, 0
    v_mov_b32 v183, 0
    v_mov_b32 v184, 0
    v_mov_b32 v185, 0
    v_mov_b32 v186, 0
    v_mov_b32 v187, 0
    v_mov_b32 v188, 0
    v_mov_b32 v189, 0
    v_mov_b32 v190, 0
    v_mov_b32 v191, 0
    v_mov_b32 v192, 0
    v_mov_b32 v193, 0
    v_mov_b32 v194, 0
    v_mov_b32 v195, 0
    v_mov_b32 v196, 0
    v_mov_b32 v197, 0
    v_mov_b32 v198, 0
    v_mov_b32 v199, 0
    v_mov_b32 v200, 0
    v_mov_b32 v201, 0
    v_mov_b32 v202, 0
    v_mov_b32 v203, 0
    v_mov_b32 v204, 0
    v_mov_b32 v205, 0
    v_mov_b32 v206, 0
    v_mov_b32 v207, 0
    v_mov_b32 v208, 0
    v_mov_b32 v209, 0
    v_mov_b32 v210, 0
    v_mov_b32 v211, 0
    v_mov_b32 v212, 0
    v_mov_b32 v213, 0
    v_mov_b32 v214, 0
    v_mov_b32 v215, 0
    s_mov_b32 s28, 0
    v_mov_b32 v1, 1
    v_mov_b32 v2, s79
    s_waitcnt vmcnt(0)
    ds_add_u32 v2, v1 offset:8
    s_barrier
    ds_read_b128 v[16:19], v4 offset:0
    ds_read_b128 v[32:35], v11 offset:0
    ds_read_b128 v[20:23], v4 offset:2048
    ds_read_b128 v[24:27], v5 offset:0
    ds_read_b128 v[28:31], v5 offset:2048
    ds_read_b128 v[36:39], v11 offset:2048
    ds_read_b128 v[40:43], v11 offset:4096
    ds_read_b128 v[44:47], v11 offset:6144
    ds_read_b128 v[48:51], v11 offset:8192
    ds_read_b128 v[52:55], v11 offset:10240
    ds_read_b128 v[56:59], v11 offset:12288
    s_add_u32 s28, s28, 1
    s_cmp_eq_u32 s28, 5
    s_cselect_b32 s29, s31, 30720
    s_cselect_b32 s28, 0, s28
    v_add_u32 v4, s29, v4
    v_add_u32 v5, s29, v5
    v_add_u32 v11, s29, v11
    s_mov_b32 s30, 15
    .p2align 6
cloop_31:
    s_waitcnt lgkmcnt(0)
    s_barrier
    v_mfma_f32_16x16x32_bf16 v[104:107], v[16:19], v[32:35], v[104:107]
    ds_read_b128 v[60:63], v4 offset:0
    v_mfma_f32_16x16x32_bf16 v[108:111], v[16:19], v[36:39], v[108:111]
    ds_read_b128 v[76:79], v11 offset:0
    v_mfma_f32_16x16x32_bf16 v[112:115], v[16:19], v[40:43], v[112:115]
    ds_read_b128 v[64:67], v4 offset:2048
    v_mfma_f32_16x16x32_bf16 v[116:119], v[16:19], v[44:47], v[116:119]
    ds_read_b128 v[68:71], v5 offset:0
    v_mfma_f32_16x16x32_bf16 v[120:123], v[16:19], v[48:51], v[120:123]
    ds_read_b128 v[72:75], v5 offset:2048
    v_mfma_f32_16x16x32_bf16 v[124:127], v[16:19], v[52:55], v[124:127]
    ds_read_b128 v[80:83], v11 offset:2048
    v_mfma_f32_16x16x32_bf16 v[128:131], v[16:19], v[56:59], v[128:131]
    ds_read_b128 v[84:87], v11 offset:4096
    v_mfma_f32_16x16x32_bf16 v[132:135], v[20:23], v[32:35], v[132:135]
    ds_read_b128 v[88:91], v11 offset:6144
    v_mfma_f32_16x16x32_bf16 v[136:139], v[20:23], v[36:39], v[136:139]
    ds_read_b128 v[92:95], v11 offset:8192
    v_mfma_f32_16x16x32_bf16 v[140:143], v[20:23], v[40:43], v[140:143]
    ds_read_b128 v[96:99], v11 offset:10240
    v_mfma_f32_16x16x32_bf16 v[144:147], v[20:23], v[44:47], v[144:147]
    ds_read_b128 v[100:103], v11 offset:12288
    v_mfma_f32_16x16x32_bf16 v[148:151], v[20:23], v[48:51], v[148:151]
    s_add_u32 s28, s28, 1
    v_mfma_f32_16x16x32_bf16 v[152:155], v[20:23], v[52:55], v[152:155]
    s_cmp_eq_u32 s28, 5
    v_mfma_f32_16x16x32_bf16 v[156:159], v[20:23], v[56:59], v[156:159]
    s_cselect_b32 s29, s31, 30720
    v_mfma_f32_16x16x32_bf16 v[160:163], v[24:27], v[32:35], v[160:163]
    s_cselect_b32 s28, 0, s28
    v_mfma_f32_16x16x32_bf16 v[164:167], v[24:27], v[36:39], v[164:167]
    v_add_u32 v4, s29, v4
    v_mfma_f32_16x16x32_bf16 v[168:171], v[24:27], v[40:43], v[168:171]
    v_add_u32 v5, s29, v5
    v_mfma_f32_16x16x32_bf16 v[172:175], v[24:27], v[44:47], v[172:175]
    v_add_u32 v11, s29, v11
    v_mfma_f32_16x16x32_bf16 v[176:179], v[24:27], v[48:51], v[176:179]
    v_mfma_f32_16x16x32_bf16 v[180:183], v[24:27], v[52:55], v[180:183]
    v_mfma_f32_16x16x32_bf16 v[184:187], v[24:27], v[56:59], v[184:187]
    v_mfma_f32_16x16x32_bf16 v[188:191], v[28:31], v[32:35], v[188:191]
    v_mfma_f32_16x16x32_bf16 v[192:195], v[28:31], v[36:39], v[192:195]
    v_mfma_f32_16x16x32_bf16 v[196:199], v[28:31], v[40:43], v[196:199]
    v_mfma_f32_16x16x32_bf16 v[200:203], v[28:31], v[44:47], v[200:203]
    v_mfma_f32_16x16x32_bf16 v[204:207], v[28:31], v[48:51], v[204:207]
    v_mfma_f32_16x16x32_bf16 v[208:211], v[28:31], v[52:55], v[208:211]
    v_mfma_f32_16x16x32_bf16 v[212:215], v[28:31], v[56:59], v[212:215]
    s_waitcnt lgkmcnt(0)
    s_barrier
    v_mfma_f32_16x16x32_bf16 v[104:107], v[60:63], v[76:79], v[104:107]
    ds_read_b128 v[16:19], v4 offset:0
    v_mfma_f32_16x16x32_bf16 v[108:111], v[60:63], v[80:83], v[108:111]
    ds_read_b128 v[32:35], v11 offset:0
    v_mfma_f32_16x16x32_bf16 v[112:115], v[60:63], v[84:87], v[112:115]
    ds_read_b128 v[20:23], v4 offset:2048
    v_mfma_f32_16x16x32_bf16 v[116:119], v[60:63], v[88:91], v[116:119]
    ds_read_b128 v[24:27], v5 offset:0
    v_mfma_f32_16x16x32_bf16 v[120:123], v[60:63], v[92:95], v[120:123]
    ds_read_b128 v[28:31], v5 offset:2048
    v_mfma_f32_16x16x32_bf16 v[124:127], v[60:63], v[96:99], v[124:127]
    ds_read_b128 v[36:39], v11 offset:2048
    v_mfma_f32_16x16x32_bf16 v[128:131], v[60:63], v[100:103], v[128:131]
    ds_read_b128 v[40:43], v11 offset:4096
    v_mfma_f32_16x16x32_bf16 v[132:135], v[64:67], v[76:79], v[132:135]
    ds_read_b128 v[44:47], v11 offset:6144
    v_mfma_f32_16x16x32_bf16 v[136:139], v[64:67], v[80:83], v[136:139]
    ds_read_b128 v[48:51], v11 offset:8192
    v_mfma_f32_16x16x32_bf16 v[140:143], v[64:67], v[84:87], v[140:143]
    ds_read_b128 v[52:55], v11 offset:10240
    v_mfma_f32_16x16x32_bf16 v[144:147], v[64:67], v[88:91], v[144:147]
    ds_read_b128 v[56:59], v11 offset:12288
    v_mfma_f32_16x16x32_bf16 v[148:151], v[64:67], v[92:95], v[148:151]
    s_add_u32 s28, s28, 1
    v_mfma_f32_16x16x32_bf16 v[152:155], v[64:67], v[96:99], v[152:155]
    s_cmp_eq_u32 s28, 5
    v_mfma_f32_16x16x32_bf16 v[156:159], v[64:67], v[100:103], v[156:159]
    s_cselect_b32 s29, s31, 30720
    v_mfma_f32_16x16x32_bf16 v[160:163], v[68:71], v[76:79], v[160:163]
    s_cselect_b32 s28, 0, s28
    v_mfma_f32_16x16x32_bf16 v[164:167], v[68:71], v[80:83], v[164:167]
    v_add_u32 v4, s29, v4
    v_mfma_f32_16x16x32_bf16 v[168:171], v[68:71], v[84:87], v[168:171]
    v_add_u32 v5, s29, v5
    v_mfma_f32_16x16x32_bf16 v[172:175], v[68:71], v[88:91], v[172:175]
    v_add_u32 v11, s29, v11
    v_mfma_f32_16x16x32_bf16 v[176:179], v[68:71], v[92:95], v[176:179]
    v_mfma_f32_16x16x32_bf16 v[180:183], v[68:71], v[96:99], v[180:183]
    v_mfma_f32_16x16x32_bf16 v[184:187], v[68:71], v[100:103], v[184:187]
    v_mfma_f32_16x16x32_bf16 v[188:191], v[72:75], v[76:79], v[188:191]
    v_mfma_f32_16x16x32_bf16 v[192:195], v[72:75], v[80:83], v[192:195]
    v_mfma_f32_16x16x32_bf16 v[196:199], v[72:75], v[84:87], v[196:199]
    v_mfma_f32_16x16x32_bf16 v[200:203], v[72:75], v[88:91], v[200:203]
    v_mfma_f32_16x16x32_bf16 v[204:207], v[72:75], v[92:95], v[204:207]
    v_mfma_f32_16x16x32_bf16 v[208:211], v[72:75], v[96:99], v[208:211]
    v_mfma_f32_16x16x32_bf16 v[212:215], v[72:75], v[100:103], v[212:215]
    s_sub_u32 s30, s30, 1
    s_cmp_lg_u32 s30, 0
    s_cbranch_scc1 cloop_31
    s_add_u32 s44, s72, 0
    s_addc_u32 s45, s73, 0
    s_mov_b32 s46, 4096
    s_mov_b32 s47, 0x20000
    buffer_load_dwordx4 v[244:247], v248, s[44:47], s43 offen
    v_lshlrev_b32 v2, 4, v0
    s_mul_i32 s24, s3, 24576
    v_add_u32 v3, s24, v2
    s_xor_b32 s25, s3, 2
    s_mul_i32 s24, s25, 24576
    v_add_u32 v2, s24, v2
    s_waitcnt lgkmcnt(0)
    s_barrier
    v_mfma_f32_16x16x32_bf16 v[104:107], v[16:19], v[32:35], v[104:107]
    ds_read_b128 v[60:63], v4 offset:0
    v_mfma_f32_16x16x32_bf16 v[108:111], v[16:19], v[36:39], v[108:111]
    ds_read_b128 v[76:79], v11 offset:0
    v_mfma_f32_16x16x32_bf16 v[112:115], v[16:19], v[40:43], v[112:115]
    ds_read_b128 v[64:67], v4 offset:2048
    v_mfma_f32_16x16x32_bf16 v[116:119], v[16:19], v[44:47], v[116:119]
    ds_read_b128 v[68:71], v5 offset:0
    v_mfma_f32_16x16x32_bf16 v[120:123], v[16:19], v[48:51], v[120:123]
    ds_read_b128 v[72:75], v5 offset:2048
    v_mfma_f32_16x16x32_bf16 v[124:127], v[16:19], v[52:55], v[124:127]
    ds_read_b128 v[80:83], v11 offset:2048
    v_mfma_f32_16x16x32_bf16 v[128:131], v[16:19], v[56:59], v[128:131]
    ds_read_b128 v[84:87], v11 offset:4096
    v_mfma_f32_16x16x32_bf16 v[132:135], v[20:23], v[32:35], v[132:135]
    ds_read_b128 v[88:91], v11 offset:6144
    v_mfma_f32_16x16x32_bf16 v[136:139], v[20:23], v[36:39], v[136:139]
    ds_read_b128 v[92:95], v11 offset:8192
    v_mfma_f32_16x16x32_bf16 v[140:143], v[20:23], v[40:43], v[140:143]
    ds_read_b128 v[96:99], v11 offset:10240
    v_mfma_f32_16x16x32_bf16 v[144:147], v[20:23], v[44:47], v[144:147]
    ds_read_b128 v[100:103], v11 offset:12288
    v_mfma_f32_16x16x32_bf16 v[148:151], v[20:23], v[48:51], v[148:151]
    s_add_u32 s28, s28, 1
    v_mfma_f32_16x16x32_bf16 v[152:155], v[20:23], v[52:55], v[152:155]
    s_cmp_eq_u32 s28, 5
    v_mfma_f32_16x16x32_bf16 v[156:159], v[20:23], v[56:59], v[156:159]
    s_cselect_b32 s29, s31, 30720
    v_mfma_f32_16x16x32_bf16 v[160:163], v[24:27], v[32:35], v[160:163]
    s_cselect_b32 s28, 0, s28
    v_mfma_f32_16x16x32_bf16 v[164:167], v[24:27], v[36:39], v[164:167]
    v_add_u32 v4, s29, v4
    v_mfma_f32_16x16x32_bf16 v[168:171], v[24:27], v[40:43], v[168:171]
    v_add_u32 v5, s29, v5
    v_mfma_f32_16x16x32_bf16 v[172:175], v[24:27], v[44:47], v[172:175]
    v_add_u32 v11, s29, v11
    v_mfma_f32_16x16x32_bf16 v[176:179], v[24:27], v[48:51], v[176:179]
    v_mfma_f32_16x16x32_bf16 v[180:183], v[24:27], v[52:55], v[180:183]
    v_mfma_f32_16x16x32_bf16 v[184:187], v[24:27], v[56:59], v[184:187]
    v_mfma_f32_16x16x32_bf16 v[188:191], v[28:31], v[32:35], v[188:191]
    v_mfma_f32_16x16x32_bf16 v[192:195], v[28:31], v[36:39], v[192:195]
    v_mfma_f32_16x16x32_bf16 v[196:199], v[28:31], v[40:43], v[196:199]
    v_mfma_f32_16x16x32_bf16 v[200:203], v[28:31], v[44:47], v[200:203]
    v_mfma_f32_16x16x32_bf16 v[204:207], v[28:31], v[48:51], v[204:207]
    v_mfma_f32_16x16x32_bf16 v[208:211], v[28:31], v[52:55], v[208:211]
    v_mfma_f32_16x16x32_bf16 v[212:215], v[28:31], v[56:59], v[212:215]
    s_waitcnt lgkmcnt(0)
    s_barrier
    v_mfma_f32_16x16x32_bf16 v[160:163], v[68:71], v[76:79], v[160:163]
    v_mfma_f32_16x16x32_bf16 v[164:167], v[68:71], v[80:83], v[164:167]
    v_mfma_f32_16x16x32_bf16 v[168:171], v[68:71], v[84:87], v[168:171]
    v_mfma_f32_16x16x32_bf16 v[172:175], v[68:71], v[88:91], v[172:175]
    v_mfma_f32_16x16x32_bf16 v[176:179], v[68:71], v[92:95], v[176:179]
    ds_write_b128 v3, v[160:163] offset:0
    v_mfma_f32_16x16x32_bf16 v[180:183], v[68:71], v[96:99], v[180:183]
    ds_write_b128 v3, v[164:167] offset:1024
    v_mfma_f32_16x16x32_bf16 v[184:187], v[68:71], v[100:103], v[184:187]
    ds_write_b128 v3, v[168:171] offset:2048
    v_mfma_f32_16x16x32_bf16 v[188:191], v[72:75], v[76:79], v[188:191]
    ds_write_b128 v3, v[172:175] offset:3072
    v_mfma_f32_16x16x32_bf16 v[192:195], v[72:75], v[80:83], v[192:195]
    ds_write_b128 v3, v[176:179] offset:4096
    v_mfma_f32_16x16x32_bf16 v[196:199], v[72:75], v[84:87], v[196:199]
    ds_write_b128 v3, v[180:183] offset:5120
    v_mfma_f32_16x16x32_bf16 v[200:203], v[72:75], v[88:91], v[200:203]
    ds_write_b128 v3, v[184:187] offset:6144
    v_mfma_f32_16x16x32_bf16 v[204:207], v[72:75], v[92:95], v[204:207]
    ds_write_b128 v3, v[188:191] offset:7168
    v_mfma_f32_16x16x32_bf16 v[208:211], v[72:75], v[96:99], v[208:211]
    ds_write_b128 v3, v[192:195] offset:8192
    v_mfma_f32_16x16x32_bf16 v[212:215], v[72:75], v[100:103], v[212:215]
    ds_write_b128 v3, v[196:199] offset:9216
    v_mfma_f32_16x16x32_bf16 v[104:107], v[60:63], v[76:79], v[104:107]
    ds_write_b128 v3, v[200:203] offset:10240
    v_mfma_f32_16x16x32_bf16 v[108:111], v[60:63], v[80:83], v[108:111]
    ds_write_b128 v3, v[204:207] offset:11264
    v_mfma_f32_16x16x32_bf16 v[112:115], v[60:63], v[84:87], v[112:115]
    ds_write_b128 v3, v[208:211] offset:12288
    v_mfma_f32_16x16x32_bf16 v[116:119], v[60:63], v[88:91], v[116:119]
    ds_write_b128 v3, v[212:215] offset:13312
    v_mfma_f32_16x16x32_bf16 v[120:123], v[60:63], v[92:95], v[120:123]
    v_mfma_f32_16x16x32_bf16 v[124:127], v[60:63], v[96:99], v[124:127]
    v_mfma_f32_16x16x32_bf16 v[128:131], v[60:63], v[100:103], v[128:131]
    v_mfma_f32_16x16x32_bf16 v[132:135], v[64:67], v[76:79], v[132:135]
    v_mfma_f32_16x16x32_bf16 v[136:139], v[64:67], v[80:83], v[136:139]
    v_mfma_f32_16x16x32_bf16 v[140:143], v[64:67], v[84:87], v[140:143]
    v_mfma_f32_16x16x32_bf16 v[144:147], v[64:67], v[88:91], v[144:147]
    v_mfma_f32_16x16x32_bf16 v[148:151], v[64:67], v[92:95], v[148:151]
    v_mfma_f32_16x16x32_bf16 v[152:155], v[64:67], v[96:99], v[152:155]
    v_mfma_f32_16x16x32_bf16 v[156:159], v[64:67], v[100:103], v[156:159]
    s_waitcnt lgkmcnt(0)
    s_barrier
    ds_read_b128 v[16:19], v2 offset:0
    ds_read_b128 v[44:47], v2 offset:7168
    ds_read_b128 v[20:23], v2 offset:1024
    ds_read_b128 v[48:51], v2 offset:8192
    ds_read_b128 v[24:27], v2 offset:2048
    ds_read_b128 v[52:55], v2 offset:9216
    ds_read_b128 v[28:31], v2 offset:3072
    ds_read_b128 v[56:59], v2 offset:10240
    ds_read_b128 v[32:35], v2 offset:4096
    ds_read_b128 v[60:63], v2 offset:11264
    ds_read_b128 v[36:39], v2 offset:5120
    ds_read_b128 v[64:67], v2 offset:12288
    ds_read_b128 v[40:43], v2 offset:6144
    ds_read_b128 v[68:71], v2 offset:13312
    s_waitcnt vmcnt(0)
    v_lshlrev_b32 v72, 16, v244
    v_and_b32 v73, 0xffff0000, v244
    v_lshlrev_b32 v74, 16, v245
    v_and_b32 v75, 0xffff0000, v245
    v_lshlrev_b32 v76, 16, v246
    v_and_b32 v77, 0xffff0000, v246
    v_lshlrev_b32 v78, 16, v247
    v_and_b32 v79, 0xffff0000, v247
    s_add_u32 s14, s32, 33554432
    s_add_u32 s12, s38, s14
    s_addc_u32 s13, s39, 0
    s_mov_b32 s14, 7340032
    s_mov_b32 s15, 0x20000
    s_waitcnt lgkmcnt(12)
    v_pk_add_f32 v[104:105], v[104:105], v[16:17]
    v_pk_add_f32 v[106:107], v[106:107], v[18:19]
    v_pk_add_f32 v[132:133], v[132:133], v[44:45]
    v_pk_add_f32 v[134:135], v[134:135], v[46:47]
    v_lshlrev_b32 v80, 16, v216
    v_and_b32 v81, 0xffff0000, v216
    v_lshlrev_b32 v82, 16, v217
    v_and_b32 v83, 0xffff0000, v217
    v_lshlrev_b32 v84, 16, v218
    v_and_b32 v85, 0xffff0000, v218
    v_lshlrev_b32 v86, 16, v219
    v_and_b32 v87, 0xffff0000, v219
    v_permlane16_swap_b32 v104, v132
    v_permlane16_swap_b32 v105, v133
    v_permlane16_swap_b32 v106, v134
    v_permlane16_swap_b32 v107, v135
    v_pk_add_f32 v[104:105], v[104:105], v[72:73]
    v_pk_add_f32 v[106:107], v[106:107], v[74:75]
    v_pk_add_f32 v[132:133], v[132:133], v[76:77]
    v_pk_add_f32 v[134:135], v[134:135], v[78:79]
    v_pk_mul_f32 v[104:105], v[104:105], v[80:81]
    v_pk_mul_f32 v[106:107], v[106:107], v[82:83]
    v_pk_mul_f32 v[132:133], v[132:133], v[84:85]
    v_pk_mul_f32 v[134:135], v[134:135], v[86:87]
    v_cvt_pk_bf16_f32 v216, v104, v105
    v_cvt_pk_bf16_f32 v217, v106, v107
    v_cvt_pk_bf16_f32 v218, v132, v133
    v_cvt_pk_bf16_f32 v219, v134, v135
    buffer_store_dwordx4 v[216:219], v15, s[12:15], s42 offen sc1
    s_add_u32 s42, s42, 4096
    s_waitcnt lgkmcnt(10)
    v_pk_add_f32 v[108:109], v[108:109], v[20:21]
    v_pk_add_f32 v[110:111], v[110:111], v[22:23]
    v_pk_add_f32 v[136:137], v[136:137], v[48:49]
    v_pk_add_f32 v[138:139], v[138:139], v[50:51]
    v_lshlrev_b32 v80, 16, v220
    v_and_b32 v81, 0xffff0000, v220
    v_lshlrev_b32 v82, 16, v221
    v_and_b32 v83, 0xffff0000, v221
    v_lshlrev_b32 v84, 16, v222
    v_and_b32 v85, 0xffff0000, v222
    v_lshlrev_b32 v86, 16, v223
    v_and_b32 v87, 0xffff0000, v223
    v_permlane16_swap_b32 v108, v136
    v_permlane16_swap_b32 v109, v137
    v_permlane16_swap_b32 v110, v138
    v_permlane16_swap_b32 v111, v139
    v_pk_add_f32 v[108:109], v[108:109], v[72:73]
    v_pk_add_f32 v[110:111], v[110:111], v[74:75]
    v_pk_add_f32 v[136:137], v[136:137], v[76:77]
    v_pk_add_f32 v[138:139], v[138:139], v[78:79]
    v_pk_mul_f32 v[108:109], v[108:109], v[80:81]
    v_pk_mul_f32 v[110:111], v[110:111], v[82:83]
    v_pk_mul_f32 v[136:137], v[136:137], v[84:85]
    v_pk_mul_f32 v[138:139], v[138:139], v[86:87]
    v_cvt_pk_bf16_f32 v220, v108, v109
    v_cvt_pk_bf16_f32 v221, v110, v111
    v_cvt_pk_bf16_f32 v222, v136, v137
    v_cvt_pk_bf16_f32 v223, v138, v139
    buffer_store_dwordx4 v[220:223], v15, s[12:15], s42 offen sc1
    s_add_u32 s42, s42, 4096
    s_waitcnt lgkmcnt(8)
    v_pk_add_f32 v[112:113], v[112:113], v[24:25]
    v_pk_add_f32 v[114:115], v[114:115], v[26:27]
    v_pk_add_f32 v[140:141], v[140:141], v[52:53]
    v_pk_add_f32 v[142:143], v[142:143], v[54:55]
    v_lshlrev_b32 v80, 16, v224
    v_and_b32 v81, 0xffff0000, v224
    v_lshlrev_b32 v82, 16, v225
    v_and_b32 v83, 0xffff0000, v225
    v_lshlrev_b32 v84, 16, v226
    v_and_b32 v85, 0xffff0000, v226
    v_lshlrev_b32 v86, 16, v227
    v_and_b32 v87, 0xffff0000, v227
    v_permlane16_swap_b32 v112, v140
    v_permlane16_swap_b32 v113, v141
    v_permlane16_swap_b32 v114, v142
    v_permlane16_swap_b32 v115, v143
    v_pk_add_f32 v[112:113], v[112:113], v[72:73]
    v_pk_add_f32 v[114:115], v[114:115], v[74:75]
    v_pk_add_f32 v[140:141], v[140:141], v[76:77]
    v_pk_add_f32 v[142:143], v[142:143], v[78:79]
    v_pk_mul_f32 v[112:113], v[112:113], v[80:81]
    v_pk_mul_f32 v[114:115], v[114:115], v[82:83]
    v_pk_mul_f32 v[140:141], v[140:141], v[84:85]
    v_pk_mul_f32 v[142:143], v[142:143], v[86:87]
    v_cvt_pk_bf16_f32 v224, v112, v113
    v_cvt_pk_bf16_f32 v225, v114, v115
    v_cvt_pk_bf16_f32 v226, v140, v141
    v_cvt_pk_bf16_f32 v227, v142, v143
    buffer_store_dwordx4 v[224:227], v15, s[12:15], s42 offen sc1
    s_add_u32 s42, s42, 4096
    s_waitcnt lgkmcnt(6)
    v_pk_add_f32 v[116:117], v[116:117], v[28:29]
    v_pk_add_f32 v[118:119], v[118:119], v[30:31]
    v_pk_add_f32 v[144:145], v[144:145], v[56:57]
    v_pk_add_f32 v[146:147], v[146:147], v[58:59]
    v_lshlrev_b32 v80, 16, v228
    v_and_b32 v81, 0xffff0000, v228
    v_lshlrev_b32 v82, 16, v229
    v_and_b32 v83, 0xffff0000, v229
    v_lshlrev_b32 v84, 16, v230
    v_and_b32 v85, 0xffff0000, v230
    v_lshlrev_b32 v86, 16, v231
    v_and_b32 v87, 0xffff0000, v231
    v_permlane16_swap_b32 v116, v144
    v_permlane16_swap_b32 v117, v145
    v_permlane16_swap_b32 v118, v146
    v_permlane16_swap_b32 v119, v147
    v_pk_add_f32 v[116:117], v[116:117], v[72:73]
    v_pk_add_f32 v[118:119], v[118:119], v[74:75]
    v_pk_add_f32 v[144:145], v[144:145], v[76:77]
    v_pk_add_f32 v[146:147], v[146:147], v[78:79]
    v_pk_mul_f32 v[116:117], v[116:117], v[80:81]
    v_pk_mul_f32 v[118:119], v[118:119], v[82:83]
    v_pk_mul_f32 v[144:145], v[144:145], v[84:85]
    v_pk_mul_f32 v[146:147], v[146:147], v[86:87]
    v_cvt_pk_bf16_f32 v228, v116, v117
    v_cvt_pk_bf16_f32 v229, v118, v119
    v_cvt_pk_bf16_f32 v230, v144, v145
    v_cvt_pk_bf16_f32 v231, v146, v147
    buffer_store_dwordx4 v[228:231], v15, s[12:15], s42 offen sc1
    s_add_u32 s42, s42, 4096
    s_waitcnt lgkmcnt(4)
    v_pk_add_f32 v[120:121], v[120:121], v[32:33]
    v_pk_add_f32 v[122:123], v[122:123], v[34:35]
    v_pk_add_f32 v[148:149], v[148:149], v[60:61]
    v_pk_add_f32 v[150:151], v[150:151], v[62:63]
    v_lshlrev_b32 v80, 16, v232
    v_and_b32 v81, 0xffff0000, v232
    v_lshlrev_b32 v82, 16, v233
    v_and_b32 v83, 0xffff0000, v233
    v_lshlrev_b32 v84, 16, v234
    v_and_b32 v85, 0xffff0000, v234
    v_lshlrev_b32 v86, 16, v235
    v_and_b32 v87, 0xffff0000, v235
    v_permlane16_swap_b32 v120, v148
    v_permlane16_swap_b32 v121, v149
    v_permlane16_swap_b32 v122, v150
    v_permlane16_swap_b32 v123, v151
    v_pk_add_f32 v[120:121], v[120:121], v[72:73]
    v_pk_add_f32 v[122:123], v[122:123], v[74:75]
    v_pk_add_f32 v[148:149], v[148:149], v[76:77]
    v_pk_add_f32 v[150:151], v[150:151], v[78:79]
    v_pk_mul_f32 v[120:121], v[120:121], v[80:81]
    v_pk_mul_f32 v[122:123], v[122:123], v[82:83]
    v_pk_mul_f32 v[148:149], v[148:149], v[84:85]
    v_pk_mul_f32 v[150:151], v[150:151], v[86:87]
    v_cvt_pk_bf16_f32 v232, v120, v121
    v_cvt_pk_bf16_f32 v233, v122, v123
    v_cvt_pk_bf16_f32 v234, v148, v149
    v_cvt_pk_bf16_f32 v235, v150, v151
    buffer_store_dwordx4 v[232:235], v15, s[12:15], s42 offen sc1
    s_add_u32 s42, s42, 4096
    s_waitcnt lgkmcnt(2)
    v_pk_add_f32 v[124:125], v[124:125], v[36:37]
    v_pk_add_f32 v[126:127], v[126:127], v[38:39]
    v_pk_add_f32 v[152:153], v[152:153], v[64:65]
    v_pk_add_f32 v[154:155], v[154:155], v[66:67]
    v_lshlrev_b32 v80, 16, v236
    v_and_b32 v81, 0xffff0000, v236
    v_lshlrev_b32 v82, 16, v237
    v_and_b32 v83, 0xffff0000, v237
    v_lshlrev_b32 v84, 16, v238
    v_and_b32 v85, 0xffff0000, v238
    v_lshlrev_b32 v86, 16, v239
    v_and_b32 v87, 0xffff0000, v239
    v_permlane16_swap_b32 v124, v152
    v_permlane16_swap_b32 v125, v153
    v_permlane16_swap_b32 v126, v154
    v_permlane16_swap_b32 v127, v155
    v_pk_add_f32 v[124:125], v[124:125], v[72:73]
    v_pk_add_f32 v[126:127], v[126:127], v[74:75]
    v_pk_add_f32 v[152:153], v[152:153], v[76:77]
    v_pk_add_f32 v[154:155], v[154:155], v[78:79]
    v_pk_mul_f32 v[124:125], v[124:125], v[80:81]
    v_pk_mul_f32 v[126:127], v[126:127], v[82:83]
    v_pk_mul_f32 v[152:153], v[152:153], v[84:85]
    v_pk_mul_f32 v[154:155], v[154:155], v[86:87]
    v_cvt_pk_bf16_f32 v236, v124, v125
    v_cvt_pk_bf16_f32 v237, v126, v127
    v_cvt_pk_bf16_f32 v238, v152, v153
    v_cvt_pk_bf16_f32 v239, v154, v155
    buffer_store_dwordx4 v[236:239], v15, s[12:15], s42 offen sc1
    s_add_u32 s42, s42, 4096
    s_waitcnt lgkmcnt(0)
    v_pk_add_f32 v[128:129], v[128:129], v[40:41]
    v_pk_add_f32 v[130:131], v[130:131], v[42:43]
    v_pk_add_f32 v[156:157], v[156:157], v[68:69]
    v_pk_add_f32 v[158:159], v[158:159], v[70:71]
    v_lshlrev_b32 v80, 16, v240
    v_and_b32 v81, 0xffff0000, v240
    v_lshlrev_b32 v82, 16, v241
    v_and_b32 v83, 0xffff0000, v241
    v_lshlrev_b32 v84, 16, v242
    v_and_b32 v85, 0xffff0000, v242
    v_lshlrev_b32 v86, 16, v243
    v_and_b32 v87, 0xffff0000, v243
    v_permlane16_swap_b32 v128, v156
    v_permlane16_swap_b32 v129, v157
    v_permlane16_swap_b32 v130, v158
    v_permlane16_swap_b32 v131, v159
    v_pk_add_f32 v[128:129], v[128:129], v[72:73]
    v_pk_add_f32 v[130:131], v[130:131], v[74:75]
    v_pk_add_f32 v[156:157], v[156:157], v[76:77]
    v_pk_add_f32 v[158:159], v[158:159], v[78:79]
    v_pk_mul_f32 v[128:129], v[128:129], v[80:81]
    v_pk_mul_f32 v[130:131], v[130:131], v[82:83]
    v_pk_mul_f32 v[156:157], v[156:157], v[84:85]
    v_pk_mul_f32 v[158:159], v[158:159], v[86:87]
    v_cvt_pk_bf16_f32 v240, v128, v129
    v_cvt_pk_bf16_f32 v241, v130, v131
    v_cvt_pk_bf16_f32 v242, v156, v157
    v_cvt_pk_bf16_f32 v243, v158, v159
    buffer_store_dwordx4 v[240:243], v15, s[12:15], s42 offen sc1
    s_add_u32 s42, s42, 4096
    s_and_b32 s18, s2, 7
    s_lshr_b32 s19, s2, 3
    s_and_b32 s16, s18, 3
    s_lshl_b32 s16, s16, 2
    s_and_b32 s20, s19, 3
    s_add_u32 s16, s16, s20
    s_lshr_b32 s17, s18, 2
    s_lshl_b32 s17, s17, 3
    s_lshr_b32 s20, s19, 2
    s_add_u32 s17, s17, s20
    s_mov_b32 s31, 4294844416
    s_and_b32 s21, s3, 1
    s_lshr_b32 s22, s3, 1
    v_and_b32 v15, 15, v0
    v_lshlrev_b32 v15, 11, v15
    v_bfe_u32 v6, v0, 4, 1
    v_lshl_add_u32 v15, v6, 5, v15
    v_bfe_u32 v6, v0, 5, 1
    v_lshl_add_u32 v15, v6, 4, v15
    s_lshl_b32 s43, s16, 7
    s_lshl_b32 s24, s21, 6
    s_add_u32 s43, s43, s24
    s_lshl_b32 s24, s22, 5
    s_add_u32 s43, s43, s24
    s_lshl_b32 s42, s43, 11
    s_lshl_b32 s24, s17, 7
    s_add_u32 s42, s42, s24
    s_add_u32 s48, s42, 32768
    v_and_b32 v1, 15, v0
    v_lshrrev_b32 v2, 4, v0
    v_lshrrev_b32 v3, 1, v1
    v_xor_b32 v3, v2, v3
    v_lshlrev_b32 v3, 4, v3
    v_lshl_add_u32 v3, v1, 7, v3
    s_lshl_b32 s24, s22, 6
    v_xor_b32 v3, s24, v3
    v_bfe_u32 v8, v0, 2, 2
    v_lshl_add_u32 v9, v2, 3, v8
    v_lshlrev_b32 v9, 8, v9
    v_and_b32 v10, 3, v0
    v_lshl_add_u32 v9, v10, 3, v9
    s_lshl_b32 s24, s22, 13
    v_add_u32 v9, s24, v9
    v_bfe_u32 v10, v0, 4, 1
    v_lshl_add_u32 v8, v10, 2, v8
    s_lshl_b32 s24, s21, 2
    s_lshl_b32 s25, s22, 1
    s_add_u32 s24, s24, s25
    v_xor_b32 v8, s24, v8
    v_xor_b32 v10, 0, v8
    v_lshl_add_u32 v4, v10, 5, v9
    v_xor_b32 v10, 1, v8
    v_lshl_add_u32 v5, v10, 5, v9
    v_xor_b32 v10, 2, v8
    v_lshl_add_u32 v6, v10, 5, v9
    v_xor_b32 v10, 3, v8
    v_lshl_add_u32 v7, v10, 5, v9
    v_bfe_u32 v8, v0, 2, 2
    v_lshl_add_u32 v8, v2, 3, v8
    v_mul_u32_u24 v8, 128, v8
    v_and_b32 v9, 3, v0
    v_lshl_add_u32 v8, v9, 3, v8
    v_add_u32 v8, 16384, v8
    s_mul_i32 s25, s22, 4096
    v_add_u32 v8, s25, v8
    v_bfe_u32 v9, v0, 3, 1
    v_bfe_u32 v10, v0, 4, 1
    v_lshl_add_u32 v9, v10, 1, v9
    v_xor_b32 v10, 0, v9
    v_lshl_add_u32 v11, v10, 5, v8
    v_xor_b32 v10, 1, v9
    v_lshl_add_u32 v12, v10, 5, v8
    v_xor_b32 v10, 2, v9
    v_lshl_add_u32 v13, v10, 5, v8
    v_xor_b32 v10, 3, v9
    v_lshl_add_u32 v14, v10, 5, v8
    v_mov_b32 v80, 0
    v_mov_b32 v81, 0
    v_mov_b32 v82, 0
    v_mov_b32 v83, 0
    v_mov_b32 v84, 0
    v_mov_b32 v85, 0
    v_mov_b32 v86, 0
    v_mov_b32 v87, 0
    v_mov_b32 v88, 0
    v_mov_b32 v89, 0
    v_mov_b32 v90, 0
    v_mov_b32 v91, 0
    v_mov_b32 v92, 0
    v_mov_b32 v93, 0
    v_mov_b32 v94, 0
    v_mov_b32 v95, 0
    v_mov_b32 v96, 0
    v_mov_b32 v97, 0
    v_mov_b32 v98, 0
    v_mov_b32 v99, 0
    v_mov_b32 v100, 0
    v_mov_b32 v101, 0
    v_mov_b32 v102, 0
    v_mov_b32 v103, 0
    v_mov_b32 v104, 0
    v_mov_b32 v105, 0
    v_mov_b32 v106, 0
    v_mov_b32 v107, 0
    v_mov_b32 v108, 0
    v_mov_b32 v109, 0
    v_mov_b32 v110, 0
    v_mov_b32 v111, 0
    v_mov_b32 v112, 0
    v_mov_b32 v113, 0
    v_mov_b32 v114, 0
    v_mov_b32 v115, 0
    v_mov_b32 v116, 0
    v_mov_b32 v117, 0
    v_mov_b32 v118, 0
    v_mov_b32 v119, 0
    v_mov_b32 v120, 0
    v_mov_b32 v121, 0
    v_mov_b32 v122, 0
    v_mov_b32 v123, 0
    v_mov_b32 v124, 0
    v_mov_b32 v125, 0
    v_mov_b32 v126, 0
    v_mov_b32 v127, 0
    v_mov_b32 v128, 0
    v_mov_b32 v129, 0
    v_mov_b32 v130, 0
    v_mov_b32 v131, 0
    v_mov_b32 v132, 0
    v_mov_b32 v133, 0
    v_mov_b32 v134, 0
    v_mov_b32 v135, 0
    v_mov_b32 v136, 0
    v_mov_b32 v137, 0
    v_mov_b32 v138, 0
    v_mov_b32 v139, 0
    v_mov_b32 v140, 0
    v_mov_b32 v141, 0
    v_mov_b32 v142, 0
    v_mov_b32 v143, 0
    s_mov_b32 s28, 0
    v_mov_b32 v1, 1
    v_mov_b32 v2, s79
    s_waitcnt vmcnt(0)
    ds_add_u32 v2, v1 offset:16
    s_barrier
    ds_read_b64_tr_b16 v[16:17], v4 offset:0
    ds_read_b64_tr_b16 v[18:19], v4 offset:1024
    ds_read_b64_tr_b16 v[32:33], v11 offset:0
    ds_read_b64_tr_b16 v[34:35], v11 offset:512
    ds_read_b64_tr_b16 v[20:21], v5 offset:0
    ds_read_b64_tr_b16 v[22:23], v5 offset:1024
    ds_read_b64_tr_b16 v[24:25], v6 offset:0
    ds_read_b64_tr_b16 v[26:27], v6 offset:1024
    ds_read_b64_tr_b16 v[28:29], v7 offset:0
    ds_read_b64_tr_b16 v[30:31], v7 offset:1024
    ds_read_b64_tr_b16 v[36:37], v12 offset:0
    ds_read_b64_tr_b16 v[38:39], v12 offset:512
    ds_read_b64_tr_b16 v[40:41], v13 offset:0
    ds_read_b64_tr_b16 v[42:43], v13 offset:512
    ds_read_b64_tr_b16 v[44:45], v14 offset:0
    ds_read_b64_tr_b16 v[46:47], v14 offset:512
    s_add_u32 s28, s28, 1
    s_cmp_eq_u32 s28, 6
    s_cselect_b32 s29, s31, 24576
    s_cselect_b32 s28, 0, s28
    v_add_u32 v4, s29, v4
    v_add_u32 v5, s29, v5
    v_add_u32 v6, s29, v6
    v_add_u32 v7, s29, v7
    v_add_u32 v11, s29, v11
    v_add_u32 v12, s29, v12
    v_add_u32 v13, s29, v13
    v_add_u32 v14, s29, v14
    s_mov_b32 s30, 13
    .p2align 6
cloop_32:
    s_waitcnt lgkmcnt(0)
    s_barrier
    v_mfma_f32_16x16x32_bf16 v[80:83], v[32:35], v[16:19], v[80:83]
    ds_read_b64_tr_b16 v[48:49], v4 offset:0
    ds_read_b64_tr_b16 v[50:51], v4 offset:1024
    ds_read_b64_tr_b16 v[64:65], v11 offset:0
    v_mfma_f32_16x16x32_bf16 v[84:87], v[36:39], v[16:19], v[84:87]
    ds_read_b64_tr_b16 v[66:67], v11 offset:512
    ds_read_b64_tr_b16 v[52:53], v5 offset:0
    ds_read_b64_tr_b16 v[54:55], v5 offset:1024
    v_mfma_f32_16x16x32_bf16 v[88:91], v[40:43], v[16:19], v[88:91]
    ds_read_b64_tr_b16 v[56:57], v6 offset:0
    ds_read_b64_tr_b16 v[58:59], v6 offset:1024
    ds_read_b64_tr_b16 v[60:61], v7 offset:0
    v_mfma_f32_16x16x32_bf16 v[92:95], v[44:47], v[16:19], v[92:95]
    ds_read_b64_tr_b16 v[62:63], v7 offset:1024
    ds_read_b64_tr_b16 v[68:69], v12 offset:0
    ds_read_b64_tr_b16 v[70:71], v12 offset:512
    v_mfma_f32_16x16x32_bf16 v[96:99], v[32:35], v[20:23], v[96:99]
    ds_read_b64_tr_b16 v[72:73], v13 offset:0
    ds_read_b64_tr_b16 v[74:75], v13 offset:512
    ds_read_b64_tr_b16 v[76:77], v14 offset:0
    v_mfma_f32_16x16x32_bf16 v[100:103], v[36:39], v[20:23], v[100:103]
    ds_read_b64_tr_b16 v[78:79], v14 offset:512
    s_add_u32 s28, s28, 1
    s_cmp_eq_u32 s28, 6
    v_mfma_f32_16x16x32_bf16 v[104:107], v[40:43], v[20:23], v[104:107]
    s_cselect_b32 s29, s31, 24576
    s_cselect_b32 s28, 0, s28
    v_add_u32 v4, s29, v4
    v_mfma_f32_16x16x32_bf16 v[108:111], v[44:47], v[20:23], v[108:111]
    v_add_u32 v5, s29, v5
    v_add_u32 v6, s29, v6
    v_add_u32 v7, s29, v7
    v_mfma_f32_16x16x32_bf16 v[112:115], v[32:35], v[24:27], v[112:115]
    v_add_u32 v11, s29, v11
    v_add_u32 v12, s29, v12
    v_add_u32 v13, s29, v13
    v_mfma_f32_16x16x32_bf16 v[116:119], v[36:39], v[24:27], v[116:119]
    v_add_u32 v14, s29, v14
    v_mfma_f32_16x16x32_bf16 v[120:123], v[40:43], v[24:27], v[120:123]
    v_mfma_f32_16x16x32_bf16 v[124:127], v[44:47], v[24:27], v[124:127]
    v_mfma_f32_16x16x32_bf16 v[128:131], v[32:35], v[28:31], v[128:131]
    v_mfma_f32_16x16x32_bf16 v[132:135], v[36:39], v[28:31], v[132:135]
    v_mfma_f32_16x16x32_bf16 v[136:139], v[40:43], v[28:31], v[136:139]
    v_mfma_f32_16x16x32_bf16 v[140:143], v[44:47], v[28:31], v[140:143]
    s_waitcnt lgkmcnt(0)
    s_barrier
    v_mfma_f32_16x16x32_bf16 v[80:83], v[64:67], v[48:51], v[80:83]
    ds_read_b64_tr_b16 v[16:17], v4 offset:0
    ds_read_b64_tr_b16 v[18:19], v4 offset:1024
    ds_read_b64_tr_b16 v[32:33], v11 offset:0
    v_mfma_f32_16x16x32_bf16 v[84:87], v[68:71], v[48:51], v[84:87]
    ds_read_b64_tr_b16 v[34:35], v11 offset:512
    ds_read_b64_tr_b16 v[20:21], v5 offset:0
    ds_read_b64_tr_b16 v[22:23], v5 offset:1024
    v_mfma_f32_16x16x32_bf16 v[88:91], v[72:75], v[48:51], v[88:91]
    ds_read_b64_tr_b16 v[24:25], v6 offset:0
    ds_read_b64_tr_b16 v[26:27], v6 offset:1024
    ds_read_b64_tr_b16 v[28:29], v7 offset:0
    v_mfma_f32_16x16x32_bf16 v[92:95], v[76:79], v[48:51], v[92:95]
    ds_read_b64_tr_b16 v[30:31], v7 offset:1024
    ds_read_b64_tr_b16 v[36:37], v12 offset:0
    ds_read_b64_tr_b16 v[38:39], v12 offset:512
    v_mfma_f32_16x16x32_bf16 v[96:99], v[64:67], v[52:55], v[96:99]
    ds_read_b64_tr_b16 v[40:41], v13 offset:0
    ds_read_b64_tr_b16 v[42:43], v13 offset:512
    ds_read_b64_tr_b16 v[44:45], v14 offset:0
    v_mfma_f32_16x16x32_bf16 v[100:103], v[68:71], v[52:55], v[100:103]
    ds_read_b64_tr_b16 v[46:47], v14 offset:512
    s_add_u32 s28, s28, 1
    s_cmp_eq_u32 s28, 6
    v_mfma_f32_16x16x32_bf16 v[104:107], v[72:75], v[52:55], v[104:107]
    s_cselect_b32 s29, s31, 24576
    s_cselect_b32 s28, 0, s28
    v_add_u32 v4, s29, v4
    v_mfma_f32_16x16x32_bf16 v[108:111], v[76:79], v[52:55], v[108:111]
    v_add_u32 v5, s29, v5
    v_add_u32 v6, s29, v6
    v_add_u32 v7, s29, v7
    v_mfma_f32_16x16x32_bf16 v[112:115], v[64:67], v[56:59], v[112:115]
    v_add_u32 v11, s29, v11
    v_add_u32 v12, s29, v12
    v_add_u32 v13, s29, v13
    v_mfma_f32_16x16x32_bf16 v[116:119], v[68:71], v[56:59], v[116:119]
    v_add_u32 v14, s29, v14
    v_mfma_f32_16x16x32_bf16 v[120:123], v[72:75], v[56:59], v[120:123]
    v_mfma_f32_16x16x32_bf16 v[124:127], v[76:79], v[56:59], v[124:127]
    v_mfma_f32_16x16x32_bf16 v[128:131], v[64:67], v[60:63], v[128:131]
    v_mfma_f32_16x16x32_bf16 v[132:135], v[68:71], v[60:63], v[132:135]
    v_mfma_f32_16x16x32_bf16 v[136:139], v[72:75], v[60:63], v[136:139]
    v_mfma_f32_16x16x32_bf16 v[140:143], v[76:79], v[60:63], v[140:143]
    s_sub_u32 s30, s30, 1
    s_cmp_lg_u32 s30, 0
    s_cbranch_scc1 cloop_32
    s_add_u32 s14, s32, 8388608
    s_add_u32 s12, s38, s14
    s_addc_u32 s13, s39, 0
    s_mov_b32 s14, 4194304
    s_mov_b32 s15, 0x20000
    buffer_load_dwordx4 v[160:163], v15, s[12:15], s42 offen offset:0
    buffer_load_dwordx4 v[164:167], v15, s[12:15], s42 offen offset:64
    buffer_load_dwordx4 v[168:171], v15, s[12:15], s48 offen offset:0
    buffer_load_dwordx4 v[172:175], v15, s[12:15], s48 offen offset:64
    v_lshlrev_b32 v2, 4, v0
    s_mul_i32 s24, s3, 8192
    v_add_u32 v3, s24, v2
    s_xor_b32 s25, s3, 2
    s_mul_i32 s24, s25, 8192
    v_add_u32 v2, s24, v2
    s_waitcnt lgkmcnt(0)
    s_barrier
    v_mfma_f32_16x16x32_bf16 v[80:83], v[32:35], v[16:19], v[80:83]
    ds_read_b64_tr_b16 v[48:49], v4 offset:0
    ds_read_b64_tr_b16 v[50:51], v4 offset:1024
    ds_read_b64_tr_b16 v[64:65], v11 offset:0
    v_mfma_f32_16x16x32_bf16 v[84:87], v[36:39], v[16:19], v[84:87]
    ds_read_b64_tr_b16 v[66:67], v11 offset:512
    ds_read_b64_tr_b16 v[52:53], v5 offset:0
    ds_read_b64_tr_b16 v[54:55], v5 offset:1024
    v_mfma_f32_16x16x32_bf16 v[88:91], v[40:43], v[16:19], v[88:91]
    ds_read_b64_tr_b16 v[56:57], v6 offset:0
    ds_read_b64_tr_b16 v[58:59], v6 offset:1024
    ds_read_b64_tr_b16 v[60:61], v7 offset:0
    v_mfma_f32_16x16x32_bf16 v[92:95], v[44:47], v[16:19], v[92:95]
    ds_read_b64_tr_b16 v[62:63], v7 offset:1024
    ds_read_b64_tr_b16 v[68:69], v12 offset:0
    ds_read_b64_tr_b16 v[70:71], v12 offset:512
    v_mfma_f32_16x16x32_bf16 v[96:99], v[32:35], v[20:23], v[96:99]
    ds_read_b64_tr_b16 v[72:73], v13 offset:0
    ds_read_b64_tr_b16 v[74:75], v13 offset:512
    ds_read_b64_tr_b16 v[76:77], v14 offset:0
    v_mfma_f32_16x16x32_bf16 v[100:103], v[36:39], v[20:23], v[100:103]
    ds_read_b64_tr_b16 v[78:79], v14 offset:512
    s_add_u32 s28, s28, 1
    s_cmp_eq_u32 s28, 6
    v_mfma_f32_16x16x32_bf16 v[104:107], v[40:43], v[20:23], v[104:107]
    s_cselect_b32 s29, s31, 24576
    s_cselect_b32 s28, 0, s28
    v_add_u32 v4, s29, v4
    v_mfma_f32_16x16x32_bf16 v[108:111], v[44:47], v[20:23], v[108:111]
    v_add_u32 v5, s29, v5
    v_add_u32 v6, s29, v6
    v_add_u32 v7, s29, v7
    v_mfma_f32_16x16x32_bf16 v[112:115], v[32:35], v[24:27], v[112:115]
    v_add_u32 v11, s29, v11
    v_add_u32 v12, s29, v12
    v_add_u32 v13, s29, v13
    v_mfma_f32_16x16x32_bf16 v[116:119], v[36:39], v[24:27], v[116:119]
    v_add_u32 v14, s29, v14
    v_mfma_f32_16x16x32_bf16 v[120:123], v[40:43], v[24:27], v[120:123]
    v_mfma_f32_16x16x32_bf16 v[124:127], v[44:47], v[24:27], v[124:127]
    v_mfma_f32_16x16x32_bf16 v[128:131], v[32:35], v[28:31], v[128:131]
    v_mfma_f32_16x16x32_bf16 v[132:135], v[36:39], v[28:31], v[132:135]
    v_mfma_f32_16x16x32_bf16 v[136:139], v[40:43], v[28:31], v[136:139]
    v_mfma_f32_16x16x32_bf16 v[140:143], v[44:47], v[28:31], v[140:143]
    s_waitcnt lgkmcnt(0)
    s_barrier
    v_mfma_f32_16x16x32_bf16 v[112:115], v[64:67], v[56:59], v[112:115]
    v_mfma_f32_16x16x32_bf16 v[116:119], v[68:71], v[56:59], v[116:119]
    v_mfma_f32_16x16x32_bf16 v[120:123], v[72:75], v[56:59], v[120:123]
    v_mfma_f32_16x16x32_bf16 v[124:127], v[76:79], v[56:59], v[124:127]
    v_mfma_f32_16x16x32_bf16 v[128:131], v[64:67], v[60:63], v[128:131]
    ds_write_b128 v3, v[112:115] offset:0
    v_mfma_f32_16x16x32_bf16 v[132:135], v[68:71], v[60:63], v[132:135]
    ds_write_b128 v3, v[116:119] offset:1024
    v_mfma_f32_16x16x32_bf16 v[136:139], v[72:75], v[60:63], v[136:139]
    ds_write_b128 v3, v[120:123] offset:2048
    v_mfma_f32_16x16x32_bf16 v[140:143], v[76:79], v[60:63], v[140:143]
    ds_write_b128 v3, v[124:127] offset:3072
    v_mfma_f32_16x16x32_bf16 v[80:83], v[64:67], v[48:51], v[80:83]
    ds_write_b128 v3, v[128:131] offset:4096
    v_mfma_f32_16x16x32_bf16 v[84:87], v[68:71], v[48:51], v[84:87]
    ds_write_b128 v3, v[132:135] offset:5120
    v_mfma_f32_16x16x32_bf16 v[88:91], v[72:75], v[48:51], v[88:91]
    ds_write_b128 v3, v[136:139] offset:6144
    v_mfma_f32_16x16x32_bf16 v[92:95], v[76:79], v[48:51], v[92:95]
    ds_write_b128 v3, v[140:143] offset:7168
    v_mfma_f32_16x16x32_bf16 v[96:99], v[64:67], v[52:55], v[96:99]
    v_mfma_f32_16x16x32_bf16 v[100:103], v[68:71], v[52:55], v[100:103]
    v_mfma_f32_16x16x32_bf16 v[104:107], v[72:75], v[52:55], v[104:107]
    v_mfma_f32_16x16x32_bf16 v[108:111], v[76:79], v[52:55], v[108:111]
    s_waitcnt lgkmcnt(0)
    s_barrier
    ds_read_b128 v[16:19], v2 offset:0
    ds_read_b128 v[20:23], v2 offset:1024
    ds_read_b128 v[24:27], v2 offset:2048
    ds_read_b128 v[28:31], v2 offset:3072
    ds_read_b128 v[32:35], v2 offset:4096
    ds_read_b128 v[36:39], v2 offset:5120
    ds_read_b128 v[40:43], v2 offset:6144
    ds_read_b128 v[44:47], v2 offset:7168
    s_add_u32 s24, s38, 41943040
    s_addc_u32 s25, s39, 0
    s_cmp_eq_u32 s33, 0
    s_cselect_b32 s12, s24, s76
    s_cselect_b32 s13, s25, s77
    s_mov_b32 s14, 4194304
    s_mov_b32 s15, 0x20000
    v_mov_b32 v56, 0
    v_mov_b32 v57, 0
    v_mov_b32 v58, 0
    v_mov_b32 v59, 0
    v_mov_b32 v60, 0
    v_mov_b32 v61, 0
    v_mov_b32 v62, 0
    v_mov_b32 v63, 0
    s_waitcnt vmcnt(0)
    s_waitcnt lgkmcnt(6)
    v_pk_add_f32 v[80:81], v[80:81], v[16:17]
    v_pk_add_f32 v[82:83], v[82:83], v[18:19]
    v_pk_add_f32 v[84:85], v[84:85], v[20:21]
    v_pk_add_f32 v[86:87], v[86:87], v[22:23]
    v_lshlrev_b32 v48, 16, v160
    v_and_b32 v49, 0xffff0000, v160
    v_lshlrev_b32 v50, 16, v161
    v_and_b32 v51, 0xffff0000, v161
    v_lshlrev_b32 v52, 16, v162
    v_and_b32 v53, 0xffff0000, v162
    v_lshlrev_b32 v54, 16, v163
    v_and_b32 v55, 0xffff0000, v163
    v_permlane16_swap_b32 v80, v84
    v_permlane16_swap_b32 v81, v85
    v_permlane16_swap_b32 v82, v86
    v_permlane16_swap_b32 v83, v87
    v_pk_add_f32 v[80:81], v[80:81], v[48:49]
    v_pk_add_f32 v[82:83], v[82:83], v[50:51]
    v_pk_add_f32 v[84:85], v[84:85], v[52:53]
    v_pk_add_f32 v[86:87], v[86:87], v[54:55]
    v_cvt_pk_bf16_f32 v160, v80, v81
    v_cvt_pk_bf16_f32 v161, v82, v83
    v_cvt_pk_bf16_f32 v162, v84, v85
    v_cvt_pk_bf16_f32 v163, v86, v87
    buffer_store_dwordx4 v[160:163], v15, s[12:15], s42 offen offset:0 sc1
    v_pk_add_f32 v[56:57], v[56:57], v[80:81]
    v_pk_fma_f32 v[58:59], v[80:81], v[80:81], v[58:59]
    v_pk_add_f32 v[56:57], v[56:57], v[82:83]
    v_pk_fma_f32 v[58:59], v[82:83], v[82:83], v[58:59]
    v_pk_add_f32 v[56:57], v[56:57], v[84:85]
    v_pk_fma_f32 v[58:59], v[84:85], v[84:85], v[58:59]
    v_pk_add_f32 v[56:57], v[56:57], v[86:87]
    v_pk_fma_f32 v[58:59], v[86:87], v[86:87], v[58:59]
    s_waitcnt lgkmcnt(4)
    v_pk_add_f32 v[88:89], v[88:89], v[24:25]
    v_pk_add_f32 v[90:91], v[90:91], v[26:27]
    v_pk_add_f32 v[92:93], v[92:93], v[28:29]
    v_pk_add_f32 v[94:95], v[94:95], v[30:31]
    v_lshlrev_b32 v48, 16, v164
    v_and_b32 v49, 0xffff0000, v164
    v_lshlrev_b32 v50, 16, v165
    v_and_b32 v51, 0xffff0000, v165
    v_lshlrev_b32 v52, 16, v166
    v_and_b32 v53, 0xffff0000, v166
    v_lshlrev_b32 v54, 16, v167
    v_and_b32 v55, 0xffff0000, v167
    v_permlane16_swap_b32 v88, v92
    v_permlane16_swap_b32 v89, v93
    v_permlane16_swap_b32 v90, v94
    v_permlane16_swap_b32 v91, v95
    v_pk_add_f32 v[88:89], v[88:89], v[48:49]
    v_pk_add_f32 v[90:91], v[90:91], v[50:51]
    v_pk_add_f32 v[92:93], v[92:93], v[52:53]
    v_pk_add_f32 v[94:95], v[94:95], v[54:55]
    v_cvt_pk_bf16_f32 v164, v88, v89
    v_cvt_pk_bf16_f32 v165, v90, v91
    v_cvt_pk_bf16_f32 v166, v92, v93
    v_cvt_pk_bf16_f32 v167, v94, v95
    buffer_store_dwordx4 v[164:167], v15, s[12:15], s42 offen offset:64 sc1
    v_pk_add_f32 v[56:57], v[56:57], v[88:89]
    v_pk_fma_f32 v[58:59], v[88:89], v[88:89], v[58:59]
    v_pk_add_f32 v[56:57], v[56:57], v[90:91]
    v_pk_fma_f32 v[58:59], v[90:91], v[90:91], v[58:59]
    v_pk_add_f32 v[56:57], v[56:57], v[92:93]
    v_pk_fma_f32 v[58:59], v[92:93], v[92:93], v[58:59]
    v_pk_add_f32 v[56:57], v[56:57], v[94:95]
    v_pk_fma_f32 v[58:59], v[94:95], v[94:95], v[58:59]
    s_waitcnt lgkmcnt(2)
    v_pk_add_f32 v[96:97], v[96:97], v[32:33]
    v_pk_add_f32 v[98:99], v[98:99], v[34:35]
    v_pk_add_f32 v[100:101], v[100:101], v[36:37]
    v_pk_add_f32 v[102:103], v[102:103], v[38:39]
    v_lshlrev_b32 v48, 16, v168
    v_and_b32 v49, 0xffff0000, v168
    v_lshlrev_b32 v50, 16, v169
    v_and_b32 v51, 0xffff0000, v169
    v_lshlrev_b32 v52, 16, v170
    v_and_b32 v53, 0xffff0000, v170
    v_lshlrev_b32 v54, 16, v171
    v_and_b32 v55, 0xffff0000, v171
    v_permlane16_swap_b32 v96, v100
    v_permlane16_swap_b32 v97, v101
    v_permlane16_swap_b32 v98, v102
    v_permlane16_swap_b32 v99, v103
    v_pk_add_f32 v[96:97], v[96:97], v[48:49]
    v_pk_add_f32 v[98:99], v[98:99], v[50:51]
    v_pk_add_f32 v[100:101], v[100:101], v[52:53]
    v_pk_add_f32 v[102:103], v[102:103], v[54:55]
    v_cvt_pk_bf16_f32 v168, v96, v97
    v_cvt_pk_bf16_f32 v169, v98, v99
    v_cvt_pk_bf16_f32 v170, v100, v101
    v_cvt_pk_bf16_f32 v171, v102, v103
    buffer_store_dwordx4 v[168:171], v15, s[12:15], s48 offen offset:0 sc1
    v_pk_add_f32 v[60:61], v[60:61], v[96:97]
    v_pk_fma_f32 v[62:63], v[96:97], v[96:97], v[62:63]
    v_pk_add_f32 v[60:61], v[60:61], v[98:99]
    v_pk_fma_f32 v[62:63], v[98:99], v[98:99], v[62:63]
    v_pk_add_f32 v[60:61], v[60:61], v[100:101]
    v_pk_fma_f32 v[62:63], v[100:101], v[100:101], v[62:63]
    v_pk_add_f32 v[60:61], v[60:61], v[102:103]
    v_pk_fma_f32 v[62:63], v[102:103], v[102:103], v[62:63]
    s_waitcnt lgkmcnt(0)
    v_pk_add_f32 v[104:105], v[104:105], v[40:41]
    v_pk_add_f32 v[106:107], v[106:107], v[42:43]
    v_pk_add_f32 v[108:109], v[108:109], v[44:45]
    v_pk_add_f32 v[110:111], v[110:111], v[46:47]
    v_lshlrev_b32 v48, 16, v172
    v_and_b32 v49, 0xffff0000, v172
    v_lshlrev_b32 v50, 16, v173
    v_and_b32 v51, 0xffff0000, v173
    v_lshlrev_b32 v52, 16, v174
    v_and_b32 v53, 0xffff0000, v174
    v_lshlrev_b32 v54, 16, v175
    v_and_b32 v55, 0xffff0000, v175
    v_permlane16_swap_b32 v104, v108
    v_permlane16_swap_b32 v105, v109
    v_permlane16_swap_b32 v106, v110
    v_permlane16_swap_b32 v107, v111
    v_pk_add_f32 v[104:105], v[104:105], v[48:49]
    v_pk_add_f32 v[106:107], v[106:107], v[50:51]
    v_pk_add_f32 v[108:109], v[108:109], v[52:53]
    v_pk_add_f32 v[110:111], v[110:111], v[54:55]
    v_cvt_pk_bf16_f32 v172, v104, v105
    v_cvt_pk_bf16_f32 v173, v106, v107
    v_cvt_pk_bf16_f32 v174, v108, v109
    v_cvt_pk_bf16_f32 v175, v110, v111
    buffer_store_dwordx4 v[172:175], v15, s[12:15], s48 offen offset:64 sc1
    v_pk_add_f32 v[60:61], v[60:61], v[104:105]
    v_pk_fma_f32 v[62:63], v[104:105], v[104:105], v[62:63]
    v_pk_add_f32 v[60:61], v[60:61], v[106:107]
    v_pk_fma_f32 v[62:63], v[106:107], v[106:107], v[62:63]
    v_pk_add_f32 v[60:61], v[60:61], v[108:109]
    v_pk_fma_f32 v[62:63], v[108:109], v[108:109], v[62:63]
    v_pk_add_f32 v[60:61], v[60:61], v[110:111]
    v_pk_fma_f32 v[62:63], v[110:111], v[110:111], v[62:63]
    s_cmp_lg_u32 s33, 0
    s_cbranch_scc1 g3done_33
    v_and_b32 v2, 15, v0
    v_mul_u32_u24 v2, 144, v2
    v_bfe_u32 v6, v0, 4, 1
    v_lshl_add_u32 v2, v6, 5, v2
    v_bfe_u32 v6, v0, 5, 1
    v_lshl_add_u32 v2, v6, 4, v2
    s_mul_i32 s24, s3, 4608
    s_add_u32 s24, s24, 32768
    v_add_u32 v2, s24, v2
    ds_write_b128 v2, v[160:163] offset:0
    ds_write_b128 v2, v[164:167] offset:64
    ds_write_b128 v2, v[168:171] offset:2304
    ds_write_b128 v2, v[172:175] offset:2368
    v_add_f32 v56, v56, v57
    v_add_f32 v58, v58, v59
    v_add_f32 v60, v60, v61
    v_add_f32 v62, v62, v63
    s_nop 1
    v_permlane16_swap_b32 v56, v58
    v_permlane16_swap_b32 v60, v62
    s_nop 1
    v_add_f32 v56, v56, v58
    v_add_f32 v60, v60, v62
    s_nop 1
    v_permlane32_swap_b32 v56, v60
    s_nop 1
    v_add_f32 v56, v56, v60
    v_and_b32 v3, 15, v0
    v_lshl_add_u32 v3, v6, 4, v3
    v_lshlrev_b32 v3, 3, v3
    v_bfe_u32 v6, v0, 4, 1
    v_lshl_add_u32 v3, v6, 2, v3
    s_lshl_b32 s25, s43, 3
    s_add_u32 s44, s38, 46153728
    s_addc_u32 s45, s39, 0
    s_mov_b32 s46, 16384
    s_mov_b32 s47, 0x20000
    buffer_atomic_add_f32 v56, v3, s[44:47], s25 offen sc1
    v_bfe_u32 v3, v0, 2, 2
    v_lshrrev_b32 v4, 4, v0
    v_lshl_add_u32 v3, v4, 3, v3
    v_mul_u32_u24 v3, 144, v3
    v_and_b32 v5, 3, v0
    v_lshl_add_u32 v3, v5, 3, v3
    v_add_u32 v3, s24, v3
    v_and_b32 v5, 15, v0
    v_lshlrev_b32 v5, 12, v5
    v_lshl_add_u32 v5, v4, 4, v5
    s_lshl_b32 s24, s17, 18
    s_lshl_b32 s25, s43, 1
    s_add_u32 s24, s24, s25
    s_add_u32 s52, s38, 50331648
    s_addc_u32 s53, s39, 0
    s_mov_b32 s54, 4194304
    s_mov_b32 s55, 0x20000
    s_waitcnt lgkmcnt(0)
    ds_read_b64_tr_b16 v[16:17], v3 offset:0
    ds_read_b64_tr_b16 v[18:19], v3 offset:576
    ds_read_b64_tr_b16 v[20:21], v3 offset:32
    ds_read_b64_tr_b16 v[22:23], v3 offset:608
    ds_read_b64_tr_b16 v[24:25], v3 offset:64
    ds_read_b64_tr_b16 v[26:27], v3 offset:640
    ds_read_b64_tr_b16 v[28:29], v3 offset:96
    ds_read_b64_tr_b16 v[30:31], v3 offset:672
    s_waitcnt lgkmcnt(6)
    buffer_store_dwordx4 v[16:19], v5, s[52:55], s24 offen sc1
    s_add_u32 s24, s24, 65536
    s_waitcnt lgkmcnt(4)
    buffer_store_dwordx4 v[20:23], v5, s[52:55], s24 offen sc1
    s_add_u32 s24, s24, 65536
    s_waitcnt lgkmcnt(2)
    buffer_store_dwordx4 v[24:27], v5, s[52:55], s24 offen sc1
    s_add_u32 s24, s24, 65536
    s_waitcnt lgkmcnt(0)
    buffer_store_dwordx4 v[28:31], v5, s[52:55], s24 offen sc1
    s_add_u32 s24, s24, 65536
g3done_33:
    s_cmp_lg_u32 s33, 0
    s_cbranch_scc1 end_5
next_8:
    s_mov_b32 s33, 1
    s_mov_b32 s32, 50331648
    s_mov_b32 s79, 155712
    s_branch layer_7
    .p2align 6
prod_6:
    s_sub_u32 s3, s3, 4
    v_mov_b32 v30, s79
    v_lshrrev_b32 v1, 3, v0
    s_lshl_b32 s20, s3, 3
    v_add_u32 v1, s20, v1
    v_and_b32 v2, 7, v0
    v_lshrrev_b32 v3, 4, v0
    v_xor_b32 v3, v2, v3
    s_and_b32 s20, s3, 1
    s_lshl_b32 s20, s20, 2
    v_xor_b32 v3, s20, v3
    v_lshlrev_b32 v3, 4, v3
    v_lshlrev_b32 v2, 4, v2
    s_mov_b32 s20, 2048
    v_mul_lo_u32 v4, v1, s20
    v_add_u32 v8, v4, v3
    v_add_u32 v9, 65536, v8
    v_add_u32 v10, 131072, v8
    v_add_u32 v11, 196608, v8
    s_lshl_b32 s20, s3, 6
    v_add_u32 v1, s20, v0
    s_mov_b32 s21, 7168
    s_and_b32 s20, s17, 1
    s_mul_i32 s20, s20, 448
    s_sub_u32 s20, 3808, s20
    v_mov_b32 v24, s20
    v_mov_b32 v25, 4294967072
    v_add_u32 v2, 0, v1
    v_mul_u32_u24 v3, 2341, v2
    v_lshrrev_b32 v3, 16, v3
    v_mul_u32_u24 v4, 28, v3
    v_sub_u32 v4, v2, v4
    v_bfe_u32 v5, v3, 3, 1
    v_lshlrev_b32 v5, 1, v5
    v_xor_b32 v4, v4, v5
    v_mul_lo_u32 v3, v3, s21
    v_cmp_gt_u32 vcc, 14, v4
    v_lshl_add_u32 v3, v4, 4, v3
    s_nop 0
    v_cndmask_b32 v6, v25, v24, vcc
    v_add_u32 v12, v6, v3
    v_add_u32 v2, 256, v1
    v_mul_u32_u24 v3, 2341, v2
    v_lshrrev_b32 v3, 16, v3
    v_mul_u32_u24 v4, 28, v3
    v_sub_u32 v4, v2, v4
    v_bfe_u32 v5, v3, 3, 1
    v_lshlrev_b32 v5, 1, v5
    v_xor_b32 v4, v4, v5
    v_mul_lo_u32 v3, v3, s21
    v_cmp_gt_u32 vcc, 14, v4
    v_lshl_add_u32 v3, v4, 4, v3
    s_nop 0
    v_cndmask_b32 v6, v25, v24, vcc
    v_add_u32 v13, v6, v3
    v_add_u32 v2, 512, v1
    v_mul_u32_u24 v3, 2341, v2
    v_lshrrev_b32 v3, 16, v3
    v_mul_u32_u24 v4, 28, v3
    v_sub_u32 v4, v2, v4
    v_bfe_u32 v5, v3, 3, 1
    v_lshlrev_b32 v5, 1, v5
    v_xor_b32 v4, v4, v5
    v_mul_lo_u32 v3, v3, s21
    v_cmp_gt_u32 vcc, 14, v4
    v_lshl_add_u32 v3, v4, 4, v3
    s_nop 0
    v_cndmask_b32 v6, v25, v24, vcc
    v_add_u32 v14, v6, v3
    v_add_u32 v2, 768, v1
    v_mul_u32_u24 v3, 2341, v2
    v_lshrrev_b32 v3, 16, v3
    v_mul_u32_u24 v4, 28, v3
    v_sub_u32 v4, v2, v4
    v_bfe_u32 v5, v3, 3, 1
    v_lshlrev_b32 v5, 1, v5
    v_xor_b32 v4, v4, v5
    v_mul_lo_u32 v3, v3, s21
    v_cmp_gt_u32 vcc, 14, v4
    v_lshl_add_u32 v3, v4, 4, v3
    s_nop 0
    v_cndmask_b32 v6, v25, v24, vcc
    v_add_u32 v15, v6, v3
    v_add_u32 v2, 1024, v1
    v_mul_u32_u24 v3, 2341, v2
    v_lshrrev_b32 v3, 16, v3
    v_mul_u32_u24 v4, 28, v3
    v_sub_u32 v4, v2, v4
    v_bfe_u32 v5, v3, 3, 1
    v_lshlrev_b32 v5, 1, v5
    v_xor_b32 v4, v4, v5
    v_mul_lo_u32 v3, v3, s21
    v_cmp_gt_u32 vcc, 14, v4
    v_lshl_add_u32 v3, v4, 4, v3
    s_nop 0
    v_cndmask_b32 v6, v25, v24, vcc
    v_add_u32 v16, v6, v3
    v_add_u32 v2, 1280, v1
    v_mul_u32_u24 v3, 2341, v2
    v_lshrrev_b32 v3, 16, v3
    v_mul_u32_u24 v4, 28, v3
    v_sub_u32 v4, v2, v4
    v_bfe_u32 v5, v3, 3, 1
    v_lshlrev_b32 v5, 1, v5
    v_xor_b32 v4, v4, v5
    v_mul_lo_u32 v3, v3, s21
    v_cmp_gt_u32 vcc, 14, v4
    v_lshl_add_u32 v3, v4, 4, v3
    s_nop 0
    v_cndmask_b32 v6, v25, v24, vcc
    v_add_u32 v17, v6, v3
    v_add_u32 v2, 1536, v1
    v_mul_u32_u24 v3, 2341, v2
    v_lshrrev_b32 v3, 16, v3
    v_mul_u32_u24 v4, 28, v3
    v_sub_u32 v4, v2, v4
    v_bfe_u32 v5, v3, 3, 1
    v_lshlrev_b32 v5, 1, v5
    v_xor_b32 v4, v4, v5
    v_mul_lo_u32 v3, v3, s21
    v_cmp_gt_u32 vcc, 14, v4
    v_lshl_add_u32 v3, v4, 4, v3
    s_nop 0
    v_cndmask_b32 v6, v25, v24, vcc
    v_add_u32 v18, v6, v3
    s_mul_i32 s20, s16, 262144
    s_sub_u32 s6, 4194304, s20
    s_add_u32 s20, s20, 12582912
    s_add_u32 s20, s20, s32
    s_mul_i32 s21, s17, 224
    s_sub_u32 s10, 7340032, s21
    s_add_u32 s21, s21, 0
    s_mov_b32 s7, 0x20000
    s_mov_b32 s11, 0x20000
    s_lshl_b32 s24, s3, 10
    s_mov_b32 s22, 0
    s_mov_b32 s23, 0
    s_mov_b32 s28, 0
    s_add_u32 s4, s38, s20
    s_addc_u32 s5, s39, 0
    s_add_u32 s8, s68, s21
    s_addc_u32 s9, s69, 0
    s_lshl_b32 s46, s33, 14
    s_add_u32 s46, s46, 46170112
    s_add_u32 s44, s38, s46
    s_addc_u32 s45, s39, 0
    s_mov_b32 s46, 4096
    s_mov_b32 s47, 0x20000
    v_mov_b32 v5, 0x10000
    v_mov_b32 v1, 0x10000
    v_mov_b32 v6, 16
    s_lshr_b32 s52, s2, 5
    s_and_b32 s53, s2, 1
    s_lshl_b32 s53, s53, 7
    s_lshl_b32 s54, s52, 8
    s_add_u32 s55, s54, s53
    v_writelane_b32 v5, s55, 0
    s_sub_u32 s55, 3840, s54
    s_add_u32 s55, s55, s53
    v_writelane_b32 v5, s55, 1
    s_sub_u32 s55, 4096, s54
    s_cmp_eq_u32 s2, 0
    s_cselect_b32 s55, 2048, s55
    s_and_b32 s53, s2, 31
    s_cselect_b32 s55, 0x10000, s55
    v_writelane_b32 v5, s55, 2
    s_lshl_b32 s55, s16, 8
    v_writelane_b32 v1, s55, 0
    s_add_u32 s55, s55, 128
    v_writelane_b32 v1, s55, 1
    s_lshr_b32 s55, s16, 3
    s_add_u32 s55, s55, 16
    v_writelane_b32 v6, s55, 0
    v_mov_b32 v3, 1
    s_waitcnt vmcnt(0)
    ds_add_u32 v30, v3 offset:0
    s_cmp_eq_u32 s3, 0
    s_cbranch_scc1 w0skip_34
    s_mov_b32 s23, 0
    s_add_u32 m0, s24, 61440
    s_nop 0
    buffer_load_dwordx4 v12, s[8:11], s23 offen lds
    s_add_u32 m0, s24, 65536
    s_nop 0
    buffer_load_dwordx4 v13, s[8:11], s23 offen lds
    s_add_u32 m0, s24, 69632
    s_nop 0
    buffer_load_dwordx4 v14, s[8:11], s23 offen lds
    s_add_u32 m0, s24, 73728
    s_nop 0
    buffer_load_dwordx4 v15, s[8:11], s23 offen lds
    s_add_u32 m0, s24, 77824
    s_nop 0
    buffer_load_dwordx4 v16, s[8:11], s23 offen lds
    s_add_u32 m0, s24, 81920
    s_nop 0
    buffer_load_dwordx4 v17, s[8:11], s23 offen lds
    s_add_u32 m0, s24, 86016
    s_nop 0
    buffer_load_dwordx4 v18, s[8:11], s23 offen lds
    s_mov_b32 s23, 458752
    s_add_u32 m0, s24, 106496
    s_nop 0
    buffer_load_dwordx4 v12, s[8:11], s23 offen lds
    s_add_u32 m0, s24, 110592
    s_nop 0
    buffer_load_dwordx4 v13, s[8:11], s23 offen lds
    s_add_u32 m0, s24, 114688
    s_nop 0
    buffer_load_dwordx4 v14, s[8:11], s23 offen lds
    s_add_u32 m0, s24, 118784
    s_nop 0
    buffer_load_dwordx4 v15, s[8:11], s23 offen lds
    s_add_u32 m0, s24, 122880
    s_nop 0
    buffer_load_dwordx4 v16, s[8:11], s23 offen lds
    s_add_u32 m0, s24, 126976
    s_nop 0
    buffer_load_dwordx4 v17, s[8:11], s23 offen lds
    s_add_u32 m0, s24, 131072
    s_nop 0
    buffer_load_dwordx4 v18, s[8:11], s23 offen lds
w0skip_34:
    s_mov_b32 s48, 0x40000
    s_cmp_eq_u32 s3, 0
    s_cselect_b32 s50, 512, 1
    s_cselect_b32 s51, 0, 4
    v_add_u32 v4, s51, v30
fsp_39:
    ds_read_b32 v2, v4 offset:0
    s_sub_u32 s48, s48, 1
    s_waitcnt lgkmcnt(0)
    v_readfirstlane_b32 s49, v2
    s_cmp_eq_u32 s48, 0
    s_cbranch_scc1 fw0_35
    s_cmp_ge_u32 s49, s50
    s_cbranch_scc1 fw0_35
    s_sleep 1
    s_branch fsp_39
fw0_35:
    s_cmp_lg_u32 s3, 0
    s_cbranch_scc1 fok_38
    s_mov_b32 s48, 0x4000
    buffer_atomic_add v3, v5, s[44:47], 0 offen sc0 sc1
    s_mov_b32 s23, 0
    s_add_u32 m0, s24, 61440
    s_nop 0
    buffer_load_dwordx4 v12, s[8:11], s23 offen lds
    s_add_u32 m0, s24, 65536
    s_nop 0
    buffer_load_dwordx4 v13, s[8:11], s23 offen lds
    s_add_u32 m0, s24, 69632
    s_nop 0
    buffer_load_dwordx4 v14, s[8:11], s23 offen lds
    s_add_u32 m0, s24, 73728
    s_nop 0
    buffer_load_dwordx4 v15, s[8:11], s23 offen lds
    s_add_u32 m0, s24, 77824
    s_nop 0
    buffer_load_dwordx4 v16, s[8:11], s23 offen lds
    s_add_u32 m0, s24, 81920
    s_nop 0
    buffer_load_dwordx4 v17, s[8:11], s23 offen lds
    s_add_u32 m0, s24, 86016
    s_nop 0
    buffer_load_dwordx4 v18, s[8:11], s23 offen lds
    s_mov_b32 s23, 458752
    s_add_u32 m0, s24, 106496
    s_nop 0
    buffer_load_dwordx4 v12, s[8:11], s23 offen lds
    s_add_u32 m0, s24, 110592
    s_nop 0
    buffer_load_dwordx4 v13, s[8:11], s23 offen lds
    s_add_u32 m0, s24, 114688
    s_nop 0
    buffer_load_dwordx4 v14, s[8:11], s23 offen lds
    s_add_u32 m0, s24, 118784
    s_nop 0
    buffer_load_dwordx4 v15, s[8:11], s23 offen lds
    s_add_u32 m0, s24, 122880
    s_nop 0
    buffer_load_dwordx4 v16, s[8:11], s23 offen lds
    s_add_u32 m0, s24, 126976
    s_nop 0
    buffer_load_dwordx4 v17, s[8:11], s23 offen lds
    s_add_u32 m0, s24, 131072
    s_nop 0
    buffer_load_dwordx4 v18, s[8:11], s23 offen lds
    s_waitcnt vmcnt(0)
fpoll_36:
    s_sleep 1
    v_mov_b32 v2, 0
    buffer_atomic_add v2, v1, s[44:47], 0 offen sc0 sc1
    s_sub_u32 s48, s48, 1
    s_waitcnt vmcnt(0)
    v_cmp_le_u32 vcc, v6, v2
    s_cmp_eq_u32 s48, 0
    s_cbranch_scc1 fgo_37
    s_cmp_lg_u32 vcc_lo, 3
    s_cbranch_scc1 fpoll_36
fgo_37:
    ds_write_b32 v30, v30 offset:4
fok_38:
    s_mov_b32 s22, 0
    s_add_u32 m0, s24, 45056
    s_nop 0
    buffer_load_dwordx4 v8, s[4:7], s22 offen lds
    s_add_u32 m0, s24, 49152
    s_nop 0
    buffer_load_dwordx4 v9, s[4:7], s22 offen lds
    s_add_u32 m0, s24, 53248
    s_nop 0
    buffer_load_dwordx4 v10, s[4:7], s22 offen lds
    s_add_u32 m0, s24, 57344
    s_nop 0
    buffer_load_dwordx4 v11, s[4:7], s22 offen lds
    s_mov_b32 s22, 128
    s_add_u32 m0, s24, 90112
    s_nop 0
    buffer_load_dwordx4 v8, s[4:7], s22 offen lds
    s_add_u32 m0, s24, 94208
    s_nop 0
    buffer_load_dwordx4 v9, s[4:7], s22 offen lds
    s_add_u32 m0, s24, 98304
    s_nop 0
    buffer_load_dwordx4 v10, s[4:7], s22 offen lds
    s_add_u32 m0, s24, 102400
    s_nop 0
    buffer_load_dwordx4 v11, s[4:7], s22 offen lds
    s_waitcnt vmcnt(4)
    s_barrier
    s_mov_b32 s22, 256
    s_mov_b32 s23, 917504
    s_mov_b32 s28, 0
    s_add_u32 s24, s24, 0
    s_mov_b32 m0, s24
    s_nop 0
    buffer_load_dwordx4 v8, s[4:7], s22 offen lds
    s_mov_b32 s30, 13
    .p2align 6
pfast_40:
    s_add_u32 m0, s24, 16384
    s_nop 0
    buffer_load_dwordx4 v12, s[8:11], s23 offen lds
    s_add_u32 s28, s28, 1
    s_cmp_eq_u32 s28, 3
    s_cselect_b32 s29, s31, 45056
    s_cselect_b32 s28, 0, s28
    s_add_u32 s25, s24, s29
    s_add_u32 m0, s24, 4096
    s_nop 0
    buffer_load_dwordx4 v9, s[4:7], s22 offen lds
    s_add_u32 m0, s24, 20480
    s_nop 0
    buffer_load_dwordx4 v13, s[8:11], s23 offen lds
    s_add_u32 m0, s24, 8192
    s_nop 0
    buffer_load_dwordx4 v10, s[4:7], s22 offen lds
    s_add_u32 m0, s24, 24576
    s_nop 0
    buffer_load_dwordx4 v14, s[8:11], s23 offen lds
    s_add_u32 m0, s24, 12288
    s_nop 0
    buffer_load_dwordx4 v11, s[4:7], s22 offen lds
    s_add_u32 s22, s22, 128
    s_add_u32 m0, s24, 28672
    s_nop 0
    buffer_load_dwordx4 v15, s[8:11], s23 offen lds
    s_add_u32 m0, s24, 32768
    s_nop 0
    buffer_load_dwordx4 v16, s[8:11], s23 offen lds
    s_add_u32 m0, s24, 36864
    s_nop 0
    buffer_load_dwordx4 v17, s[8:11], s23 offen lds
    s_add_u32 m0, s24, 40960
    s_nop 0
    buffer_load_dwordx4 v18, s[8:11], s23 offen lds
    s_mov_b32 m0, s25
    s_waitcnt vmcnt(11)
    s_barrier
    buffer_load_dwordx4 v8, s[4:7], s22 offen lds
    s_mov_b32 s24, s25
    s_add_u32 s23, s23, 458752
    s_sub_u32 s30, s30, 1
    s_cmp_lg_u32 s30, 0
    s_cbranch_scc1 pfast_40
    s_add_u32 m0, s24, 16384
    s_nop 0
    buffer_load_dwordx4 v12, s[8:11], s23 offen lds
    s_add_u32 m0, s24, 4096
    s_nop 0
    buffer_load_dwordx4 v9, s[4:7], s22 offen lds
    s_add_u32 m0, s24, 20480
    s_nop 0
    buffer_load_dwordx4 v13, s[8:11], s23 offen lds
    s_add_u32 m0, s24, 8192
    s_nop 0
    buffer_load_dwordx4 v10, s[4:7], s22 offen lds
    s_add_u32 m0, s24, 24576
    s_nop 0
    buffer_load_dwordx4 v14, s[8:11], s23 offen lds
    s_add_u32 m0, s24, 12288
    s_nop 0
    buffer_load_dwordx4 v11, s[4:7], s22 offen lds
    s_add_u32 m0, s24, 28672
    s_nop 0
    buffer_load_dwordx4 v15, s[8:11], s23 offen lds
    s_add_u32 m0, s24, 32768
    s_nop 0
    buffer_load_dwordx4 v16, s[8:11], s23 offen lds
    s_add_u32 m0, s24, 36864
    s_nop 0
    buffer_load_dwordx4 v17, s[8:11], s23 offen lds
    s_add_u32 m0, s24, 40960
    s_nop 0
    buffer_load_dwordx4 v18, s[8:11], s23 offen lds
    s_waitcnt vmcnt(11)
    s_barrier
    s_waitcnt vmcnt(0)
    s_barrier
    s_barrier
    s_and_b32 s18, s2, 7
    s_lshr_b32 s19, s2, 3
    s_and_b32 s16, s18, 3
    s_lshl_b32 s16, s16, 2
    s_and_b32 s20, s19, 3
    s_add_u32 s16, s16, s20
    s_lshr_b32 s17, s18, 2
    s_lshl_b32 s17, s17, 3
    s_lshr_b32 s20, s19, 2
    s_add_u32 s17, s17, s20
    s_mov_b32 s31, 4294844416
    v_lshrrev_b32 v1, 3, v0
    s_lshl_b32 s20, s3, 3
    v_add_u32 v1, s20, v1
    v_and_b32 v2, 7, v0
    v_lshrrev_b32 v3, 4, v0
    v_xor_b32 v3, v2, v3
    s_and_b32 s20, s3, 1
    s_lshl_b32 s20, s20, 2
    v_xor_b32 v3, s20, v3
    v_lshlrev_b32 v3, 4, v3
    v_lshlrev_b32 v2, 4, v2
    s_mov_b32 s20, 4096
    v_mul_lo_u32 v4, v1, s20
    v_add_u32 v8, v4, v3
    v_add_u32 v9, 131072, v8
    v_add_u32 v10, 262144, v8
    v_add_u32 v11, 393216, v8
    s_mov_b32 s20, 128
    v_mul_lo_u32 v4, v1, s20
    v_add_u32 v12, v4, v3
    v_add_u32 v13, 4096, v12
    v_add_u32 v14, 8192, v12
    v_add_u32 v15, 12288, v12
    s_mul_i32 s20, s16, 524288
    s_sub_u32 s6, 8388608, s20
    s_add_u32 s20, s20, 0
    s_mul_i32 s21, s17, 458752
    s_sub_u32 s10, 7340032, s21
    s_add_u32 s21, s21, 16777216
    s_add_u32 s21, s21, s32
    s_mov_b32 s7, 0x20000
    s_mov_b32 s11, 0x20000
    s_lshl_b32 s24, s3, 10
    s_mov_b32 s22, 0
    s_mov_b32 s23, 0
    s_mov_b32 s28, 0
    s_add_u32 s4, s70, s20
    s_addc_u32 s5, s71, 0
    s_add_u32 s8, s38, s21
    s_addc_u32 s9, s39, 0
    v_mov_b32 v3, 1
    s_mov_b32 s22, 0
    s_add_u32 m0, s24, 0
    s_nop 0
    buffer_load_dwordx4 v8, s[4:7], s22 offen lds
    s_add_u32 m0, s24, 4096
    s_nop 0
    buffer_load_dwordx4 v9, s[4:7], s22 offen lds
    s_add_u32 m0, s24, 8192
    s_nop 0
    buffer_load_dwordx4 v10, s[4:7], s22 offen lds
    s_add_u32 m0, s24, 12288
    s_nop 0
    buffer_load_dwordx4 v11, s[4:7], s22 offen lds
    s_mov_b32 s22, 128
    s_add_u32 m0, s24, 30720
    s_nop 0
    buffer_load_dwordx4 v8, s[4:7], s22 offen lds
    s_add_u32 m0, s24, 34816
    s_nop 0
    buffer_load_dwordx4 v9, s[4:7], s22 offen lds
    s_add_u32 m0, s24, 38912
    s_nop 0
    buffer_load_dwordx4 v10, s[4:7], s22 offen lds
    s_add_u32 m0, s24, 43008
    s_nop 0
    buffer_load_dwordx4 v11, s[4:7], s22 offen lds
    s_mov_b32 s22, 256
    s_add_u32 m0, s24, 61440
    s_nop 0
    buffer_load_dwordx4 v8, s[4:7], s22 offen lds
    s_add_u32 m0, s24, 65536
    s_nop 0
    buffer_load_dwordx4 v9, s[4:7], s22 offen lds
    s_add_u32 m0, s24, 69632
    s_nop 0
    buffer_load_dwordx4 v10, s[4:7], s22 offen lds
    s_add_u32 m0, s24, 73728
    s_nop 0
    buffer_load_dwordx4 v11, s[4:7], s22 offen lds
    s_mov_b32 s22, 384
    s_add_u32 m0, s24, 92160
    s_nop 0
    buffer_load_dwordx4 v8, s[4:7], s22 offen lds
    s_add_u32 m0, s24, 96256
    s_nop 0
    buffer_load_dwordx4 v9, s[4:7], s22 offen lds
    s_add_u32 m0, s24, 100352
    s_nop 0
    buffer_load_dwordx4 v10, s[4:7], s22 offen lds
    s_add_u32 m0, s24, 104448
    s_nop 0
    buffer_load_dwordx4 v11, s[4:7], s22 offen lds
    s_setprio 3
    s_add_u32 s50, s32, 47185920
    s_add_u32 s48, s38, s50
    s_addc_u32 s49, s39, 0
    s_mov_b32 s50, 524288
    s_mov_b32 s51, 0x20000
    v_lshlrev_b32 v1, 4, v0
    s_lshl_b32 s46, s16, 2
    s_add_u32 s46, s46, s3
    s_lshl_b32 s46, s46, 13
    s_add_u32 s47, s46, 4096
    s_mov_b32 s44, 0x8000
    s_sleep 52
poll_41:
    buffer_load_dwordx4 v[32:35], v1, s[48:51], s46 offen offset:0 sc1
    buffer_load_dwordx4 v[36:39], v1, s[48:51], s46 offen offset:1024 sc1
    buffer_load_dwordx4 v[40:43], v1, s[48:51], s46 offen offset:2048 sc1
    buffer_load_dwordx4 v[44:47], v1, s[48:51], s46 offen offset:3072 sc1
    buffer_load_dwordx4 v[48:51], v1, s[48:51], s47 offen offset:0 sc1
    buffer_load_dwordx4 v[52:55], v1, s[48:51], s47 offen offset:1024 sc1
    buffer_load_dwordx4 v[56:59], v1, s[48:51], s47 offen offset:2048 sc1
    buffer_load_dwordx4 v[60:63], v1, s[48:51], s47 offen offset:3072 sc1
    s_waitcnt vmcnt(0)
    v_max_u32 v2, v33, v35
    v_max3_u32 v2, v2, v37, v39
    v_max3_u32 v2, v2, v41, v43
    v_max3_u32 v2, v2, v45, v47
    v_max3_u32 v2, v2, v49, v51
    v_max3_u32 v2, v2, v53, v55
    v_max3_u32 v2, v2, v57, v59
    v_max3_u32 v2, v2, v61, v63
    v_cmp_eq_u32 vcc, -1, v2
    s_sub_u32 s44, s44, 1
    s_cmp_eq_u32 s44, 0
    s_cbranch_scc1 pollok_42
    s_cmp_eq_u64 vcc, 0
    s_cbranch_scc1 pollok_42
    s_sleep 2
    s_branch poll_41
pollok_42:
    v_pk_add_f32 v[32:33], v[32:33], v[36:37]
    v_pk_add_f32 v[34:35], v[34:35], v[38:39]
    v_pk_add_f32 v[32:33], v[32:33], v[40:41]
    v_pk_add_f32 v[34:35], v[34:35], v[42:43]
    v_pk_add_f32 v[32:33], v[32:33], v[44:45]
    v_pk_add_f32 v[34:35], v[34:35], v[46:47]
    v_pk_add_f32 v[32:33], v[32:33], v[48:49]
    v_pk_add_f32 v[34:35], v[34:35], v[50:51]
    v_pk_add_f32 v[32:33], v[32:33], v[52:53]
    v_pk_add_f32 v[34:35], v[34:35], v[54:55]
    v_pk_add_f32 v[32:33], v[32:33], v[56:57]
    v_pk_add_f32 v[34:35], v[34:35], v[58:59]
    v_pk_add_f32 v[32:33], v[32:33], v[60:61]
    v_pk_add_f32 v[34:35], v[34:35], v[62:63]
    v_mov_b32 v36, v32
    v_mov_b32 v37, v33
    v_mov_b32 v38, v34
    v_mov_b32 v39, v35
    s_nop 1
    v_permlane16_swap_b32 v32, v36
    v_permlane16_swap_b32 v33, v37
    v_permlane16_swap_b32 v34, v38
    v_permlane16_swap_b32 v35, v39
    s_nop 1
    v_add_f32 v32, v32, v36
    v_add_f32 v33, v33, v37
    v_add_f32 v34, v34, v38
    v_add_f32 v35, v35, v39
    v_mov_b32 v36, v32
    v_mov_b32 v37, v33
    v_mov_b32 v38, v34
    v_mov_b32 v39, v35
    s_nop 1
    v_permlane32_swap_b32 v32, v36
    v_permlane32_swap_b32 v33, v37
    v_permlane32_swap_b32 v34, v38
    v_permlane32_swap_b32 v35, v39
    s_nop 1
    v_add_f32 v32, v32, v36
    v_add_f32 v33, v33, v37
    v_add_f32 v34, v34, v38
    v_add_f32 v35, v35, v39
    v_mul_f32 v32, 974276901, v32
    v_mul_f32 v33, 974276901, v33
    v_mul_f32 v34, 974276901, v34
    v_mul_f32 v35, 974276901, v35
    v_fma_f32 v33, -v32, v32, v33
    v_fma_f32 v35, -v34, v34, v35
    v_max_f32 v33, 0, v33
    v_add_f32 v33, 925353388, v33
    v_max_f32 v35, 0, v35
    v_add_f32 v35, 925353388, v35
    v_rsq_f32 v40, v33
    v_rsq_f32 v41, v35
    s_nop 0
    v_mul_f32 v42, -v32, v40
    v_mul_f32 v43, -v34, v41
    v_and_b32 v2, 15, v0
    v_lshlrev_b32 v2, 3, v2
    s_lshl_b32 s46, s3, 7
    s_add_u32 s46, s46, 153600
    v_add_u32 v2, s46, v2
    ds_write_b64 v2, v[40:41]
    ds_write_b64 v2, v[42:43] offset:512
    s_waitcnt lgkmcnt(0)
    s_barrier
    s_setprio 0
    v_mov_b32 v3, 1
    s_lshl_b32 s46, s33, 14
    s_add_u32 s46, s46, 46174208
    s_add_u32 s44, s38, s46
    s_addc_u32 s45, s39, 0
    s_mov_b32 s46, 4096
    s_mov_b32 s47, 0x20000
    v_mov_b32 v5, 0x10000
    v_mov_b32 v1, 0x10000
    v_mov_b32 v6, 16
    s_xor_b32 s52, s17, 1
    s_lshl_b32 s52, s52, 7
    v_writelane_b32 v5, s52, 0
    s_lshl_b32 s52, s17, 7
    v_writelane_b32 v1, s52, 0
    s_mov_b32 s48, 0x40000
    s_cmp_eq_u32 s3, 0
    s_cselect_b32 s50, 256, 1
    s_cselect_b32 s51, 0, 4
    v_add_u32 v4, s51, v30
fsp_47:
    ds_read_b32 v2, v4 offset:8
    s_sub_u32 s48, s48, 1
    s_waitcnt lgkmcnt(0)
    v_readfirstlane_b32 s49, v2
    s_cmp_eq_u32 s48, 0
    s_cbranch_scc1 fw0_43
    s_cmp_ge_u32 s49, s50
    s_cbranch_scc1 fw0_43
    s_sleep 1
    s_branch fsp_47
fw0_43:
    s_cmp_lg_u32 s3, 0
    s_cbranch_scc1 fok_46
    s_mov_b32 s48, 0x4000
    buffer_atomic_add v3, v5, s[44:47], 0 offen sc0 sc1
    s_waitcnt vmcnt(0)
fpoll_44:
    s_sleep 1
    v_mov_b32 v2, 0
    buffer_atomic_add v2, v1, s[44:47], 0 offen sc0 sc1
    s_sub_u32 s48, s48, 1
    s_waitcnt vmcnt(0)
    v_cmp_le_u32 vcc, v6, v2
    s_cmp_eq_u32 s48, 0
    s_cbranch_scc1 fgo_45
    s_cmp_lg_u32 vcc_lo, 1
    s_cbranch_scc1 fpoll_44
fgo_45:
    ds_write_b32 v30, v30 offset:12
fok_46:
    s_cmp_ge_u32 s3, 2
    s_cbranch_scc1 pl2_48
    s_mov_b32 s23, 0
    s_add_u32 m0, s24, 16384
    s_nop 0
    buffer_load_dwordx4 v12, s[8:11], s23 offen lds
    s_add_u32 m0, s24, 20480
    s_nop 0
    buffer_load_dwordx4 v13, s[8:11], s23 offen lds
    s_add_u32 m0, s24, 24576
    s_nop 0
    buffer_load_dwordx4 v14, s[8:11], s23 offen lds
    s_add_u32 m0, s24, 28672
    s_nop 0
    buffer_load_dwordx4 v15, s[8:11], s23 offen lds
    s_mov_b32 s23, 14336
    s_add_u32 m0, s24, 47104
    s_nop 0
    buffer_load_dwordx4 v12, s[8:11], s23 offen lds
    s_add_u32 m0, s24, 51200
    s_nop 0
    buffer_load_dwordx4 v13, s[8:11], s23 offen lds
    s_add_u32 m0, s24, 55296
    s_nop 0
    buffer_load_dwordx4 v14, s[8:11], s23 offen lds
    s_add_u32 m0, s24, 59392
    s_nop 0
    buffer_load_dwordx4 v15, s[8:11], s23 offen lds
    s_mov_b32 s23, 28672
    s_add_u32 m0, s24, 77824
    s_nop 0
    buffer_load_dwordx4 v12, s[8:11], s23 offen lds
    s_add_u32 m0, s24, 81920
    s_nop 0
    buffer_load_dwordx4 v13, s[8:11], s23 offen lds
    s_add_u32 m0, s24, 86016
    s_nop 0
    buffer_load_dwordx4 v14, s[8:11], s23 offen lds
    s_add_u32 m0, s24, 90112
    s_nop 0
    buffer_load_dwordx4 v15, s[8:11], s23 offen lds
    s_mov_b32 s23, 43008
    s_add_u32 m0, s24, 108544
    s_nop 0
    buffer_load_dwordx4 v12, s[8:11], s23 offen lds
    s_add_u32 m0, s24, 112640
    s_nop 0
    buffer_load_dwordx4 v13, s[8:11], s23 offen lds
    s_add_u32 m0, s24, 116736
    s_nop 0
    buffer_load_dwordx4 v14, s[8:11], s23 offen lds
    s_add_u32 m0, s24, 120832
    s_nop 0
    buffer_load_dwordx4 v15, s[8:11], s23 offen lds
    s_waitcnt vmcnt(12)
    s_barrier
    s_mov_b32 s22, 512
    s_mov_b32 s23, 57344
    s_add_u32 m0, s24, 122880
    s_nop 0
    buffer_load_dwordx4 v8, s[4:7], s22 offen lds
    s_add_u32 m0, s24, 139264
    s_nop 0
    buffer_load_dwordx4 v12, s[8:11], s23 offen lds
    s_add_u32 m0, s24, 126976
    s_nop 0
    buffer_load_dwordx4 v9, s[4:7], s22 offen lds
    s_add_u32 m0, s24, 143360
    s_nop 0
    buffer_load_dwordx4 v13, s[8:11], s23 offen lds
    s_add_u32 m0, s24, 131072
    s_nop 0
    buffer_load_dwordx4 v10, s[4:7], s22 offen lds
    s_add_u32 m0, s24, 147456
    s_nop 0
    buffer_load_dwordx4 v14, s[8:11], s23 offen lds
    s_add_u32 m0, s24, 135168
    s_nop 0
    buffer_load_dwordx4 v11, s[4:7], s22 offen lds
    s_add_u32 m0, s24, 151552
    s_nop 0
    buffer_load_dwordx4 v15, s[8:11], s23 offen lds
    s_waitcnt vmcnt(16)
    s_barrier
    s_mov_b32 s22, 640
    s_mov_b32 s23, 71680
    s_add_u32 m0, s24, 0
    s_nop 0
    buffer_load_dwordx4 v8, s[4:7], s22 offen lds
    s_add_u32 m0, s24, 16384
    s_nop 0
    buffer_load_dwordx4 v12, s[8:11], s23 offen lds
    s_add_u32 m0, s24, 4096
    s_nop 0
    buffer_load_dwordx4 v9, s[4:7], s22 offen lds
    s_add_u32 m0, s24, 20480
    s_nop 0
    buffer_load_dwordx4 v13, s[8:11], s23 offen lds
    s_add_u32 m0, s24, 8192
    s_nop 0
    buffer_load_dwordx4 v10, s[4:7], s22 offen lds
    s_add_u32 m0, s24, 24576
    s_nop 0
    buffer_load_dwordx4 v14, s[8:11], s23 offen lds
    s_add_u32 m0, s24, 12288
    s_nop 0
    buffer_load_dwordx4 v11, s[4:7], s22 offen lds
    s_add_u32 m0, s24, 28672
    s_nop 0
    buffer_load_dwordx4 v15, s[8:11], s23 offen lds
    s_waitcnt vmcnt(20)
    s_barrier
    s_mov_b32 s22, 768
    s_mov_b32 s23, 86016
    s_mov_b32 s28, 1
    s_add_u32 s24, s24, 30720
    s_mov_b32 m0, s24
    s_nop 0
    buffer_load_dwordx4 v8, s[4:7], s22 offen lds
    s_mov_b32 s30, 25
    .p2align 6
pfast_50:
    s_add_u32 m0, s24, 16384
    s_nop 0
    buffer_load_dwordx4 v12, s[8:11], s23 offen lds
    s_add_u32 s28, s28, 1
    s_cmp_eq_u32 s28, 5
    s_cselect_b32 s29, s31, 30720
    s_cselect_b32 s28, 0, s28
    s_add_u32 s25, s24, s29
    s_add_u32 m0, s24, 4096
    s_nop 0
    buffer_load_dwordx4 v9, s[4:7], s22 offen lds
    s_add_u32 m0, s24, 20480
    s_nop 0
    buffer_load_dwordx4 v13, s[8:11], s23 offen lds
    s_add_u32 m0, s24, 8192
    s_nop 0
    buffer_load_dwordx4 v10, s[4:7], s22 offen lds
    s_add_u32 m0, s24, 24576
    s_nop 0
    buffer_load_dwordx4 v14, s[8:11], s23 offen lds
    s_add_u32 m0, s24, 12288
    s_nop 0
    buffer_load_dwordx4 v11, s[4:7], s22 offen lds
    s_add_u32 s22, s22, 128
    s_add_u32 m0, s24, 28672
    s_nop 0
    buffer_load_dwordx4 v15, s[8:11], s23 offen lds
    s_mov_b32 m0, s25
    s_waitcnt vmcnt(24)
    s_barrier
    buffer_load_dwordx4 v8, s[4:7], s22 offen lds
    s_mov_b32 s24, s25
    s_add_u32 s23, s23, 14336
    s_sub_u32 s30, s30, 1
    s_cmp_lg_u32 s30, 0
    s_cbranch_scc1 pfast_50
    s_add_u32 m0, s24, 16384
    s_nop 0
    buffer_load_dwordx4 v12, s[8:11], s23 offen lds
    s_add_u32 m0, s24, 4096
    s_nop 0
    buffer_load_dwordx4 v9, s[4:7], s22 offen lds
    s_add_u32 m0, s24, 20480
    s_nop 0
    buffer_load_dwordx4 v13, s[8:11], s23 offen lds
    s_add_u32 m0, s24, 8192
    s_nop 0
    buffer_load_dwordx4 v10, s[4:7], s22 offen lds
    s_add_u32 m0, s24, 24576
    s_nop 0
    buffer_load_dwordx4 v14, s[8:11], s23 offen lds
    s_add_u32 m0, s24, 12288
    s_nop 0
    buffer_load_dwordx4 v11, s[4:7], s22 offen lds
    s_add_u32 m0, s24, 28672
    s_nop 0
    buffer_load_dwordx4 v15, s[8:11], s23 offen lds
    s_waitcnt vmcnt(24)
    s_barrier
    s_waitcnt vmcnt(16)
    s_barrier
    s_waitcnt vmcnt(8)
    s_barrier
    s_waitcnt vmcnt(0)
    s_barrier
    s_branch pl3_49
pl2_48:
    s_mov_b32 s23, 0
    s_add_u32 m0, s24, 16384
    s_nop 0
    buffer_load_dwordx4 v12, s[8:11], s23 offen lds
    s_add_u32 m0, s24, 20480
    s_nop 0
    buffer_load_dwordx4 v13, s[8:11], s23 offen lds
    s_add_u32 m0, s24, 24576
    s_nop 0
    buffer_load_dwordx4 v14, s[8:11], s23 offen lds
    s_mov_b32 s23, 14336
    s_add_u32 m0, s24, 47104
    s_nop 0
    buffer_load_dwordx4 v12, s[8:11], s23 offen lds
    s_add_u32 m0, s24, 51200
    s_nop 0
    buffer_load_dwordx4 v13, s[8:11], s23 offen lds
    s_add_u32 m0, s24, 55296
    s_nop 0
    buffer_load_dwordx4 v14, s[8:11], s23 offen lds
    s_mov_b32 s23, 28672
    s_add_u32 m0, s24, 77824
    s_nop 0
    buffer_load_dwordx4 v12, s[8:11], s23 offen lds
    s_add_u32 m0, s24, 81920
    s_nop 0
    buffer_load_dwordx4 v13, s[8:11], s23 offen lds
    s_add_u32 m0, s24, 86016
    s_nop 0
    buffer_load_dwordx4 v14, s[8:11], s23 offen lds
    s_mov_b32 s23, 43008
    s_add_u32 m0, s24, 108544
    s_nop 0
    buffer_load_dwordx4 v12, s[8:11], s23 offen lds
    s_add_u32 m0, s24, 112640
    s_nop 0
    buffer_load_dwordx4 v13, s[8:11], s23 offen lds
    s_add_u32 m0, s24, 116736
    s_nop 0
    buffer_load_dwordx4 v14, s[8:11], s23 offen lds
    s_waitcnt vmcnt(9)
    s_barrier
    s_mov_b32 s22, 512
    s_mov_b32 s23, 57344
    s_add_u32 m0, s24, 122880
    s_nop 0
    buffer_load_dwordx4 v8, s[4:7], s22 offen lds
    s_add_u32 m0, s24, 139264
    s_nop 0
    buffer_load_dwordx4 v12, s[8:11], s23 offen lds
    s_add_u32 m0, s24, 126976
    s_nop 0
    buffer_load_dwordx4 v9, s[4:7], s22 offen lds
    s_add_u32 m0, s24, 143360
    s_nop 0
    buffer_load_dwordx4 v13, s[8:11], s23 offen lds
    s_add_u32 m0, s24, 131072
    s_nop 0
    buffer_load_dwordx4 v10, s[4:7], s22 offen lds
    s_add_u32 m0, s24, 147456
    s_nop 0
    buffer_load_dwordx4 v14, s[8:11], s23 offen lds
    s_add_u32 m0, s24, 135168
    s_nop 0
    buffer_load_dwordx4 v11, s[4:7], s22 offen lds
    s_waitcnt vmcnt(13)
    s_barrier
    s_mov_b32 s22, 640
    s_mov_b32 s23, 71680
    s_add_u32 m0, s24, 0
    s_nop 0
    buffer_load_dwordx4 v8, s[4:7], s22 offen lds
    s_add_u32 m0, s24, 16384
    s_nop 0
    buffer_load_dwordx4 v12, s[8:11], s23 offen lds
    s_add_u32 m0, s24, 4096
    s_nop 0
    buffer_load_dwordx4 v9, s[4:7], s22 offen lds
    s_add_u32 m0, s24, 20480
    s_nop 0
    buffer_load_dwordx4 v13, s[8:11], s23 offen lds
    s_add_u32 m0, s24, 8192
    s_nop 0
    buffer_load_dwordx4 v10, s[4:7], s22 offen lds
    s_add_u32 m0, s24, 24576
    s_nop 0
    buffer_load_dwordx4 v14, s[8:11], s23 offen lds
    s_add_u32 m0, s24, 12288
    s_nop 0
    buffer_load_dwordx4 v11, s[4:7], s22 offen lds
    s_waitcnt vmcnt(17)
    s_barrier
    s_mov_b32 s22, 768
    s_mov_b32 s23, 86016
    s_mov_b32 s28, 1
    s_add_u32 s24, s24, 30720
    s_mov_b32 m0, s24
    s_nop 0
    buffer_load_dwordx4 v8, s[4:7], s22 offen lds
    s_mov_b32 s30, 25
    .p2align 6
pfast_51:
    s_add_u32 m0, s24, 16384
    s_nop 0
    buffer_load_dwordx4 v12, s[8:11], s23 offen lds
    s_add_u32 s28, s28, 1
    s_cmp_eq_u32 s28, 5
    s_cselect_b32 s29, s31, 30720
    s_cselect_b32 s28, 0, s28
    s_add_u32 s25, s24, s29
    s_add_u32 m0, s24, 4096
    s_nop 0
    buffer_load_dwordx4 v9, s[4:7], s22 offen lds
    s_add_u32 m0, s24, 20480
    s_nop 0
    buffer_load_dwordx4 v13, s[8:11], s23 offen lds
    s_add_u32 m0, s24, 8192
    s_nop 0
    buffer_load_dwordx4 v10, s[4:7], s22 offen lds
    s_add_u32 m0, s24, 24576
    s_nop 0
    buffer_load_dwordx4 v14, s[8:11], s23 offen lds
    s_add_u32 s23, s23, 14336
    s_add_u32 m0, s24, 12288
    s_nop 0
    buffer_load_dwordx4 v11, s[4:7], s22 offen lds
    s_mov_b32 m0, s25
    s_add_u32 s22, s22, 128
    s_waitcnt vmcnt(21)
    s_barrier
    buffer_load_dwordx4 v8, s[4:7], s22 offen lds
    s_mov_b32 s24, s25
    s_sub_u32 s30, s30, 1
    s_cmp_lg_u32 s30, 0
    s_cbranch_scc1 pfast_51
    s_add_u32 m0, s24, 16384
    s_nop 0
    buffer_load_dwordx4 v12, s[8:11], s23 offen lds
    s_add_u32 m0, s24, 4096
    s_nop 0
    buffer_load_dwordx4 v9, s[4:7], s22 offen lds
    s_add_u32 m0, s24, 20480
    s_nop 0
    buffer_load_dwordx4 v13, s[8:11], s23 offen lds
    s_add_u32 m0, s24, 8192
    s_nop 0
    buffer_load_dwordx4 v10, s[4:7], s22 offen lds
    s_add_u32 m0, s24, 24576
    s_nop 0
    buffer_load_dwordx4 v14, s[8:11], s23 offen lds
    s_add_u32 m0, s24, 12288
    s_nop 0
    buffer_load_dwordx4 v11, s[4:7], s22 offen lds
    s_waitcnt vmcnt(21)
    s_barrier
    s_waitcnt vmcnt(14)
    s_barrier
    s_waitcnt vmcnt(7)
    s_barrier
    s_waitcnt vmcnt(0)
    s_barrier
pl3_49:
    s_barrier
    s_and_b32 s18, s2, 7
    s_lshr_b32 s19, s2, 3
    s_and_b32 s16, s18, 3
    s_lshl_b32 s16, s16, 2
    s_and_b32 s20, s19, 3
    s_add_u32 s16, s16, s20
    s_lshr_b32 s17, s18, 2
    s_lshl_b32 s17, s17, 3
    s_lshr_b32 s20, s19, 2
    s_add_u32 s17, s17, s20
    s_mov_b32 s31, 4294844416
    v_lshrrev_b32 v1, 3, v0
    s_lshl_b32 s20, s3, 3
    v_add_u32 v1, s20, v1
    v_and_b32 v2, 7, v0
    v_lshrrev_b32 v3, 4, v0
    v_xor_b32 v3, v2, v3
    s_and_b32 s20, s3, 1
    s_lshl_b32 s20, s20, 2
    v_xor_b32 v3, s20, v3
    v_lshlrev_b32 v3, 4, v3
    v_lshlrev_b32 v2, 4, v2
    v_lshrrev_b32 v4, 4, v0
    s_lshl_b32 s20, s3, 2
    v_add_u32 v5, s20, v4
    s_mov_b32 s20, 256
    v_mul_lo_u32 v5, v5, s20
    s_lshr_b32 s20, s3, 1
    s_lshl_b32 s20, s20, 2
    v_or_b32 v4, s20, v4
    v_lshlrev_b32 v4, 1, v4
    v_and_b32 v6, 15, v0
    v_xor_b32 v4, v4, v6
    v_lshl_add_u32 v8, v4, 4, v5
    v_add_u32 v9, 4096, v8
    v_add_u32 v10, 8192, v8
    v_add_u32 v11, 12288, v8
    s_lshl_b32 s20, s3, 6
    v_add_u32 v1, s20, v0
    s_mov_b32 s21, 128
    v_add_u32 v2, 0, v1
    v_lshrrev_b32 v3, 3, v2
    v_and_b32 v4, 7, v2
    v_bfe_u32 v5, v3, 1, 1
    v_bfe_u32 v6, v3, 3, 1
    v_lshl_add_u32 v5, v6, 1, v5
    v_lshlrev_b32 v5, 1, v5
    v_xor_b32 v4, v4, v5
    v_mul_lo_u32 v3, v3, s21
    v_lshl_add_u32 v12, v4, 4, v3
    v_add_u32 v2, 256, v1
    v_lshrrev_b32 v3, 3, v2
    v_and_b32 v4, 7, v2
    v_bfe_u32 v5, v3, 1, 1
    v_bfe_u32 v6, v3, 3, 1
    v_lshl_add_u32 v5, v6, 1, v5
    v_lshlrev_b32 v5, 1, v5
    v_xor_b32 v4, v4, v5
    v_mul_lo_u32 v3, v3, s21
    v_lshl_add_u32 v13, v4, 4, v3
    s_mul_i32 s20, s16, 458752
    s_sub_u32 s6, 7340032, s20
    s_add_u32 s20, s20, 33554432
    s_add_u32 s20, s20, s32
    s_mul_i32 s21, s17, 229376
    s_sub_u32 s10, 3670016, s21
    s_add_u32 s21, s21, 113246208
    s_mov_b32 s7, 0x20000
    s_mov_b32 s11, 0x20000
    s_lshl_b32 s24, s3, 10
    s_mov_b32 s22, 0
    s_mov_b32 s23, 0
    s_mov_b32 s28, 0
    s_add_u32 s4, s38, s20
    s_addc_u32 s5, s39, 0
    s_add_u32 s8, s38, s21
    s_addc_u32 s9, s39, 0
    v_mov_b32 v3, 1
    s_mov_b32 s23, 0
    s_add_u32 m0, s24, 16384
    s_nop 0
    buffer_load_dwordx4 v12, s[8:11], s23 offen lds
    s_add_u32 m0, s24, 20480
    s_nop 0
    buffer_load_dwordx4 v13, s[8:11], s23 offen lds
    s_mov_b32 s23, 8192
    s_add_u32 m0, s24, 40960
    s_nop 0
    buffer_load_dwordx4 v12, s[8:11], s23 offen lds
    s_add_u32 m0, s24, 45056
    s_nop 0
    buffer_load_dwordx4 v13, s[8:11], s23 offen lds
    s_mov_b32 s23, 16384
    s_add_u32 m0, s24, 65536
    s_nop 0
    buffer_load_dwordx4 v12, s[8:11], s23 offen lds
    s_add_u32 m0, s24, 69632
    s_nop 0
    buffer_load_dwordx4 v13, s[8:11], s23 offen lds
    s_mov_b32 s23, 24576
    s_add_u32 m0, s24, 90112
    s_nop 0
    buffer_load_dwordx4 v12, s[8:11], s23 offen lds
    s_add_u32 m0, s24, 94208
    s_nop 0
    buffer_load_dwordx4 v13, s[8:11], s23 offen lds
    s_barrier
    v_mov_b32 v3, 1
    s_lshl_b32 s46, s33, 14
    s_add_u32 s46, s46, 46178304
    s_add_u32 s44, s38, s46
    s_addc_u32 s45, s39, 0
    s_mov_b32 s46, 4096
    s_mov_b32 s47, 0x20000
    v_mov_b32 v5, 0x10000
    v_mov_b32 v1, 0x10000
    v_mov_b32 v6, 16
    s_xor_b32 s52, s16, 0
    s_lshl_b32 s52, s52, 7
    v_writelane_b32 v5, s52, 0
    s_lshl_b32 s52, s16, 7
    v_writelane_b32 v1, s52, 0
    s_mov_b32 s48, 0x40000
    s_cmp_eq_u32 s3, 0
    s_cselect_b32 s50, 256, 1
    s_cselect_b32 s51, 0, 4
    v_add_u32 v4, s51, v30
fsp_56:
    ds_read_b32 v2, v4 offset:16
    s_sub_u32 s48, s48, 1
    s_waitcnt lgkmcnt(0)
    v_readfirstlane_b32 s49, v2
    s_cmp_eq_u32 s48, 0
    s_cbranch_scc1 fw0_52
    s_cmp_ge_u32 s49, s50
    s_cbranch_scc1 fw0_52
    s_sleep 1
    s_branch fsp_56
fw0_52:
    s_cmp_lg_u32 s3, 0
    s_cbranch_scc1 fok_55
    s_mov_b32 s48, 0x4000
    buffer_atomic_add v3, v5, s[44:47], 0 offen sc0 sc1
    s_waitcnt vmcnt(0)
    v_readfirstlane_b32 s49, v3
    s_cmp_ge_u32 s49, 15
    s_cbranch_scc1 fgo_54
fpoll_53:
    s_sleep 1
    v_mov_b32 v2, 0
    buffer_atomic_add v2, v1, s[44:47], 0 offen sc0 sc1
    s_sub_u32 s48, s48, 1
    s_waitcnt vmcnt(0)
    v_cmp_le_u32 vcc, v6, v2
    s_cmp_eq_u32 s48, 0
    s_cbranch_scc1 fgo_54
    s_cmp_lg_u32 vcc_lo, 1
    s_cbranch_scc1 fpoll_53
fgo_54:
    ds_write_b32 v30, v30 offset:20
fok_55:
    s_mov_b32 s22, 0
    s_add_u32 m0, s24, 0
    s_nop 0
    buffer_load_dwordx4 v8, s[4:7], s22 offen lds
    s_add_u32 m0, s24, 4096
    s_nop 0
    buffer_load_dwordx4 v9, s[4:7], s22 offen lds
    s_add_u32 m0, s24, 8192
    s_nop 0
    buffer_load_dwordx4 v10, s[4:7], s22 offen lds
    s_add_u32 m0, s24, 12288
    s_nop 0
    buffer_load_dwordx4 v11, s[4:7], s22 offen lds
    s_mov_b32 s22, 16384
    s_add_u32 m0, s24, 24576
    s_nop 0
    buffer_load_dwordx4 v8, s[4:7], s22 offen lds
    s_add_u32 m0, s24, 28672
    s_nop 0
    buffer_load_dwordx4 v9, s[4:7], s22 offen lds
    s_add_u32 m0, s24, 32768
    s_nop 0
    buffer_load_dwordx4 v10, s[4:7], s22 offen lds
    s_add_u32 m0, s24, 36864
    s_nop 0
    buffer_load_dwordx4 v11, s[4:7], s22 offen lds
    s_mov_b32 s22, 32768
    s_add_u32 m0, s24, 49152
    s_nop 0
    buffer_load_dwordx4 v8, s[4:7], s22 offen lds
    s_add_u32 m0, s24, 53248
    s_nop 0
    buffer_load_dwordx4 v9, s[4:7], s22 offen lds
    s_add_u32 m0, s24, 57344
    s_nop 0
    buffer_load_dwordx4 v10, s[4:7], s22 offen lds
    s_add_u32 m0, s24, 61440
    s_nop 0
    buffer_load_dwordx4 v11, s[4:7], s22 offen lds
    s_mov_b32 s22, 49152
    s_add_u32 m0, s24, 73728
    s_nop 0
    buffer_load_dwordx4 v8, s[4:7], s22 offen lds
    s_add_u32 m0, s24, 77824
    s_nop 0
    buffer_load_dwordx4 v9, s[4:7], s22 offen lds
    s_add_u32 m0, s24, 81920
    s_nop 0
    buffer_load_dwordx4 v10, s[4:7], s22 offen lds
    s_add_u32 m0, s24, 86016
    s_nop 0
    buffer_load_dwordx4 v11, s[4:7], s22 offen lds
    s_waitcnt vmcnt(12)
    s_barrier
    s_mov_b32 s22, 65536
    s_mov_b32 s23, 32768
    s_add_u32 m0, s24, 98304
    s_nop 0
    buffer_load_dwordx4 v8, s[4:7], s22 offen lds
    s_add_u32 m0, s24, 114688
    s_nop 0
    buffer_load_dwordx4 v12, s[8:11], s23 offen lds
    s_add_u32 m0, s24, 102400
    s_nop 0
    buffer_load_dwordx4 v9, s[4:7], s22 offen lds
    s_add_u32 m0, s24, 118784
    s_nop 0
    buffer_load_dwordx4 v13, s[8:11], s23 offen lds
    s_add_u32 m0, s24, 106496
    s_nop 0
    buffer_load_dwordx4 v10, s[4:7], s22 offen lds
    s_add_u32 m0, s24, 110592
    s_nop 0
    buffer_load_dwordx4 v11, s[4:7], s22 offen lds
    s_mov_b32 s22, 81920
    s_mov_b32 s23, 40960
    s_add_u32 m0, s24, 122880
    s_nop 0
    buffer_load_dwordx4 v8, s[4:7], s22 offen lds
    s_add_u32 m0, s24, 139264
    s_nop 0
    buffer_load_dwordx4 v12, s[8:11], s23 offen lds
    s_add_u32 m0, s24, 126976
    s_nop 0
    buffer_load_dwordx4 v9, s[4:7], s22 offen lds
    s_add_u32 m0, s24, 143360
    s_nop 0
    buffer_load_dwordx4 v13, s[8:11], s23 offen lds
    s_add_u32 m0, s24, 131072
    s_nop 0
    buffer_load_dwordx4 v10, s[4:7], s22 offen lds
    s_add_u32 m0, s24, 135168
    s_nop 0
    buffer_load_dwordx4 v11, s[4:7], s22 offen lds
    s_waitcnt vmcnt(20)
    s_barrier
    s_mov_b32 s22, 98304
    s_mov_b32 s23, 49152
    s_add_u32 m0, s24, 0
    s_nop 0
    buffer_load_dwordx4 v8, s[4:7], s22 offen lds
    s_add_u32 m0, s24, 16384
    s_nop 0
    buffer_load_dwordx4 v12, s[8:11], s23 offen lds
    s_add_u32 m0, s24, 4096
    s_nop 0
    buffer_load_dwordx4 v9, s[4:7], s22 offen lds
    s_add_u32 m0, s24, 20480
    s_nop 0
    buffer_load_dwordx4 v13, s[8:11], s23 offen lds
    s_add_u32 m0, s24, 8192
    s_nop 0
    buffer_load_dwordx4 v10, s[4:7], s22 offen lds
    s_add_u32 m0, s24, 12288
    s_nop 0
    buffer_load_dwordx4 v11, s[4:7], s22 offen lds
    s_waitcnt vmcnt(22)
    s_barrier
    s_mov_b32 s22, 114688
    s_mov_b32 s23, 57344
    s_mov_b32 s28, 1
    s_add_u32 s24, s24, 24576
    s_mov_b32 m0, s24
    s_nop 0
    buffer_load_dwordx4 v8, s[4:7], s22 offen lds
    s_mov_b32 s30, 20
    .p2align 6
pfast_57:
    s_add_u32 m0, s24, 16384
    s_nop 0
    buffer_load_dwordx4 v12, s[8:11], s23 offen lds
    s_add_u32 s28, s28, 1
    s_cmp_eq_u32 s28, 6
    s_cselect_b32 s29, s31, 24576
    s_cselect_b32 s28, 0, s28
    s_add_u32 s25, s24, s29
    s_add_u32 m0, s24, 4096
    s_nop 0
    buffer_load_dwordx4 v9, s[4:7], s22 offen lds
    s_add_u32 m0, s24, 20480
    s_nop 0
    buffer_load_dwordx4 v13, s[8:11], s23 offen lds
    s_add_u32 s23, s23, 8192
    s_add_u32 m0, s24, 8192
    s_nop 0
    buffer_load_dwordx4 v10, s[4:7], s22 offen lds
    s_add_u32 m0, s24, 12288
    s_nop 0
    buffer_load_dwordx4 v11, s[4:7], s22 offen lds
    s_mov_b32 m0, s25
    s_add_u32 s22, s22, 16384
    s_waitcnt vmcnt(24)
    s_barrier
    buffer_load_dwordx4 v8, s[4:7], s22 offen lds
    s_mov_b32 s24, s25
    s_sub_u32 s30, s30, 1
    s_cmp_lg_u32 s30, 0
    s_cbranch_scc1 pfast_57
    s_add_u32 m0, s24, 16384
    s_nop 0
    buffer_load_dwordx4 v12, s[8:11], s23 offen lds
    s_add_u32 m0, s24, 4096
    s_nop 0
    buffer_load_dwordx4 v9, s[4:7], s22 offen lds
    s_add_u32 m0, s24, 20480
    s_nop 0
    buffer_load_dwordx4 v13, s[8:11], s23 offen lds
    s_add_u32 m0, s24, 8192
    s_nop 0
    buffer_load_dwordx4 v10, s[4:7], s22 offen lds
    s_add_u32 m0, s24, 12288
    s_nop 0
    buffer_load_dwordx4 v11, s[4:7], s22 offen lds
    s_waitcnt vmcnt(24)
    s_barrier
    s_waitcnt vmcnt(18)
    s_barrier
    s_waitcnt vmcnt(12)
    s_barrier
    s_waitcnt vmcnt(6)
    s_barrier
    s_waitcnt vmcnt(0)
    s_barrier
    s_barrier
    s_cmp_lg_u32 s33, 0
    s_cbranch_scc1 end_5
    s_add_u32 s3, s3, 4
    s_barrier
    s_branch next_8
end_5:
    s_endpgm
code_end:
.section .rodata,"a"
.p2align 6
.amdhsa_kernel pre_kernel
  .amdhsa_next_free_vgpr 80
  .amdhsa_next_free_sgpr 96
  .amdhsa_accum_offset 80
  .amdhsa_group_segment_fixed_size 0
  .amdhsa_kernarg_size 104
  .amdhsa_user_sgpr_count 2
  .amdhsa_user_sgpr_kernarg_segment_ptr 1
  .amdhsa_system_sgpr_workgroup_id_x 1
  .amdhsa_float_denorm_mode_32 3
.end_amdhsa_kernel
.p2align 6
.amdhsa_kernel gf_kernel
  .amdhsa_next_free_vgpr 256
  .amdhsa_next_free_sgpr 96
  .amdhsa_accum_offset 256
  .amdhsa_group_segment_fixed_size 0
  .amdhsa_kernarg_size 104
  .amdhsa_user_sgpr_count 2
  .amdhsa_user_sgpr_kernarg_segment_ptr 1
  .amdhsa_system_sgpr_workgroup_id_x 1
  .amdhsa_float_denorm_mode_32 3
.end_amdhsa_kernel
```
